```python
import torch

def _softmax(x, axis=-1):
    return torch.softmax(x, dim=axis)
def _gelu(x):
    return torch.nn.functional.gelu(x, approximate="tanh")
def _silu(x):
    return torch.nn.functional.silu(x)
def _sigmoid(x):
    return torch.sigmoid(x)
def _layernorm(x, axis=-1, eps=1e-5):
    m = x.mean(dim=axis, keepdim=True)
    v = x.var(dim=axis, keepdim=True, unbiased=False)
    return (x - m) / torch.sqrt(v + eps)
def _scatter_add(tgt, idx, src, axis=0):
    return tgt.clone().index_add_(axis, idx, src)
def _segment_sum(src, seg, n):
    out = torch.zeros((n,) + src.shape[1:], dtype=src.dtype)
    return out.index_add_(0, seg, src)
def _pad(x, pw):
    flat = tuple(v for pair in reversed(pw) for v in pair)
    return torch.nn.functional.pad(x, flat)

kernel_name = 'standalone__mpnn_edge_mlp__graph'

def setup_inputs():

    _w = (lambda a: (lambda t: t.to(torch.bfloat16) if t.is_floating_point() else t)(torch.as_tensor(a)))
    N, deg, D, De = 10000, 32, 128, max(16, 1)
    E = N * deg
    return {
        "x": _w((lambda *s: torch.randn(*s, dtype=torch.bfloat16) * 0.05)(N, D)),
        "e_attr": _w((lambda *s: torch.randn(*s, dtype=torch.bfloat16) * 0.4)(E, De)),
        "src": _w((lambda lo, hi, *s: torch.randint(lo, hi, s))(0, N, E).to(torch.int64)),
        "dst": _w((lambda lo, hi, *s: torch.randint(lo, hi, s))(0, N, E).to(torch.int64)),
        "w_msg": _w((lambda *s: torch.randn(*s, dtype=torch.bfloat16) * 0.4)(2 * D + De, D)),
        "w_upd": _w((lambda *s: torch.randn(*s, dtype=torch.bfloat16) * 0.05)(2 * D, D)),
    }

def reference(x, e_attr, src, dst, w_msg, w_upd):
    N, D = x.shape
    m_in = torch.concatenate([x[src], x[dst], e_attr], axis=-1)
    msg = _silu(m_in @ w_msg)
    agg = _segment_sum(msg, dst, N)
    return _silu(torch.concatenate([x, agg], axis=-1) @ w_upd)
```

```asm
; @launch grid=(256,1,1) block=(512,1,1) lds=161952
.amdgcn_target "amdgcn-amd-amdhsa--gfx950"
.text
.globl standalone__mpnn_edge_mlp__graph_kernel
.p2align 8
.type standalone__mpnn_edge_mlp__graph_kernel,@function
standalone__mpnn_edge_mlp__graph_kernel:
  s_cmp_ge_u32 s2, 256
  s_cbranch_scc1 K_END
  s_load_dwordx8 s[4:11], s[0:1], 0
  s_load_dwordx4 s[12:15], s[0:1], 32
  s_load_dwordx2 s[16:17], s[0:1], 48
  s_load_dwordx2 s[18:19], s[0:1], 64
  s_getpc_b64 s[20:21]
  v_lshlrev_b32 v3, 7, v0
  v_cmp_gt_u32 vcc, (K_TEXTEND - standalone__mpnn_edge_mlp__graph_kernel) / 128, v0
  s_and_saveexec_b64 s[22:23], vcc
  s_cbranch_execz K_NOCPF
  global_load_dword v232, v3, s[20:21]
K_NOCPF:
  s_mov_b64 exec, s[22:23]
  v_lshrrev_b32 v2, 6, v0
  v_and_b32 v1, 63, v0
  s_and_b32 s71, s2, 7
  s_mul_i32 s71, s71, 4096
  s_and_b32 s100, s2, 7
  s_lshl_b32 s100, s100, 1
  s_bfe_u32 s101, s2, 0x10003
  s_and_b32 s2, s2, 0xf0
  s_or_b32 s2, s2, s100
  s_or_b32 s2, s2, s101
  s_mul_i32 s60, s2, 640013
  v_readfirstlane_b32 s3, v2
  s_add_u32 s61, s60, 656396
  s_add_u32 s60, s60, 16383
  s_sub_u32 s79, s60, 640013
  s_lshr_b32 s60, s60, 14
  s_lshr_b32 s61, s61, 14
  s_lshr_b32 s79, s79, 14
  s_min_u32 s61, s61, 10000
  s_sub_u32 s63, s61, s79
  s_sub_u32 s61, s61, s60
  s_lshl_b32 s64, s79, 8
  s_sub_u32 s79, s60, s79
  s_mov_b32 s65, 0
  s_mov_b32 s66, 0
  s_mov_b32 s67, 1
  s_mov_b32 s68, 1040
  s_mov_b32 s69, 320
  s_mul_i32 s62, s3, 9344
  s_add_u32 s62, s62, 87200
  v_lshlrev_b32 v29, 4, v0
  s_mul_i32 s100, s2, 5120
  v_lshl_add_u32 v4, v0, 2, s100
  v_add_u32 v5, 4096, v4
  v_lshrrev_b32 v6, 4, v1
  v_lshlrev_b32 v2, 1, v6
  v_xor_b32 v2, v2, v1
  v_lshlrev_b32 v2, 4, v2
  s_lshl_b32 s100, s3, 12
  v_add_u32 v9, s100, v2
  s_mul_i32 s72, s3, 4352
  s_add_u32 s72, s72, 122016
  v_add_u32 v8, 8192, v29
  v_add_u32 v7, 16384, v29
  s_waitcnt lgkmcnt(0)
  s_bitcmp1_b32 s2, 0
  s_cbranch_scc1 K_LDG
  s_cmp_ge_u32 s2, 250
  s_cbranch_scc1 K_LDP
  s_mov_b32 s48, s10
  s_mov_b32 s49, s11
  s_mov_b32 s50, 1280000
  s_mov_b32 s51, 0x20000
  s_mov_b32 s52, s8
  s_mov_b32 s53, s9
  s_mov_b32 s54, 1280000
  s_mov_b32 s55, 0x20000
  s_movk_i32 s100, 0x2000
  buffer_load_dword v122, v4, s[48:51], 0 offen
  buffer_load_dword v123, v4, s[48:51], 0 offen offset:2048
  buffer_load_dword v124, v5, s[48:51], 0 offen
  buffer_load_dword v125, v5, s[48:51], 0 offen offset:2048
  buffer_load_dword v126, v4, s[48:51], s100 offen
  buffer_load_dword v127, v4, s[52:55], 0 offen
  buffer_load_dword v128, v4, s[52:55], 0 offen offset:2048
  buffer_load_dword v129, v5, s[52:55], 0 offen
  buffer_load_dword v130, v5, s[52:55], 0 offen offset:2048
  buffer_load_dword v131, v4, s[52:55], s100 offen
  s_branch K_LD3
K_LDX:
  s_lshl_b32 s100, s60, 8
  s_lshl_b32 s101, s61, 8
  s_mov_b32 s56, s4
  s_mov_b32 s57, s5
  s_add_u32 s56, s56, s100
  s_addc_u32 s57, s57, 0
  s_mov_b32 s58, s101
  s_mov_b32 s59, 0x20000
  buffer_load_dwordx4 v[204:207], v29, s[56:59], 0 offen
  buffer_load_dwordx4 v[208:211], v8, s[56:59], 0 offen
  s_branch K_LD3
K_LDP:
  s_cmp_eq_u32 s2, 250
  s_cselect_b32 s52, s12, s14
  s_cselect_b32 s53, s13, s15
  s_cmp_eq_u32 s2, 252
  s_cselect_b32 s100, 0, 32768
  s_add_u32 s52, s52, s100
  s_addc_u32 s53, s53, 0
  s_mov_b32 s54, 32768
  s_mov_b32 s55, 0x20000
  s_add_u32 m0, s72, 0
  s_nop 0
  buffer_load_dwordx4 v9, s[52:55], 0 offen offset:0 lds
  s_add_u32 m0, s72, 64
  s_nop 0
  buffer_load_dwordx4 v9, s[52:55], 0 offen offset:1024 lds
  s_add_u32 m0, s72, 128
  s_nop 0
  buffer_load_dwordx4 v9, s[52:55], 0 offen offset:2048 lds
  s_add_u32 m0, s72, 192
  s_nop 0
  buffer_load_dwordx4 v9, s[52:55], 0 offen offset:3072 lds
  s_add_u32 s48, s12, 65536
  s_addc_u32 s49, s13, 0
  s_mov_b32 s50, 4096
  s_mov_b32 s51, 0x20000
  v_and_b32 v2, 31, v1
  v_lshrrev_b32 v3, 5, v1
  v_lshlrev_b32 v3, 11, v3
  v_lshl_add_u32 v3, v2, 1, v3
  s_and_b32 s100, s3, 3
  s_lshl_b32 s100, s100, 6
  buffer_load_ushort v122, v3, s[48:51], s100 offen offset:0
  buffer_load_ushort v123, v3, s[48:51], s100 offen offset:256
  buffer_load_ushort v124, v3, s[48:51], s100 offen offset:512
  buffer_load_ushort v125, v3, s[48:51], s100 offen offset:768
  buffer_load_ushort v126, v3, s[48:51], s100 offen offset:1024
  buffer_load_ushort v127, v3, s[48:51], s100 offen offset:1280
  buffer_load_ushort v128, v3, s[48:51], s100 offen offset:1536
  buffer_load_ushort v129, v3, s[48:51], s100 offen offset:1792
  s_branch K_LDX
K_LDG:
  s_lshl_b32 s63, s63, 8
  s_mov_b32 s48, s4
  s_mov_b32 s49, s5
  s_add_u32 s48, s48, s64
  s_addc_u32 s49, s49, 0
  s_mov_b32 s50, s63
  s_mov_b32 s51, 0x20000
  s_mov_b32 s52, s12
  s_mov_b32 s53, s13
  s_mov_b32 s54, 32768
  s_mov_b32 s55, 0x20000
  buffer_load_dwordx4 v[62:65], v29, s[48:51], 0 offen
  buffer_load_dwordx4 v[66:69], v8, s[48:51], 0 offen
  buffer_load_dwordx4 v[70:73], v7, s[48:51], 0 offen
  s_add_u32 m0, s72, 0
  s_nop 0
  buffer_load_dwordx4 v9, s[52:55], 0 offen offset:0 lds
  s_add_u32 m0, s72, 64
  s_nop 0
  buffer_load_dwordx4 v9, s[52:55], 0 offen offset:1024 lds
  s_add_u32 m0, s72, 128
  s_nop 0
  buffer_load_dwordx4 v9, s[52:55], 0 offen offset:2048 lds
  s_add_u32 m0, s72, 192
  s_nop 0
  buffer_load_dwordx4 v9, s[52:55], 0 offen offset:3072 lds
K_LD3:
  s_add_u32 s44, s18, 22151168
  s_addc_u32 s45, s19, 0
  s_load_dword s70, s[44:45], 65536
  s_mov_b32 s46, 65540
  s_mov_b32 s47, 0x20000
  v_lshrrev_b32 v3, 2, v0
  v_and_b32 v6, 3, v0
  v_lshlrev_b32 v6, 4, v6
  v_lshl_add_u32 v30, v3, 7, v6
  s_mov_b32 s100, 81920
  v_mul_u32_u24 v27, s100, v3
  v_mov_b32 v196, 0
  v_mov_b32 v197, 0
  v_mov_b32 v198, 0
  v_mov_b32 v199, 0
  v_add_u32 v2, 87200, v29
  s_bitcmp1_b32 s2, 0
  s_cbranch_scc1 K_NOZ
  ds_write_b128 v2, v[196:199] offset:0
  ds_write_b128 v2, v[196:199] offset:8192
  ds_write_b128 v2, v[196:199] offset:16384
  ds_write_b128 v2, v[196:199] offset:24576
  s_cmp_lg_u32 s3, 0
  s_cbranch_scc1 K_NOZ
  ds_write_b128 v2, v[196:199] offset:32768
K_NOZ:
  ds_write_b128 v29, v[196:199] offset:18176
  ds_write_b128 v29, v[196:199] offset:26368
  ds_write_b128 v29, v[196:199] offset:34560
  ds_write_b128 v29, v[196:199] offset:42752
  ds_write_b128 v29, v[196:199] offset:50944
  v_cmp_gt_u32 vcc, 234, v0
  s_and_saveexec_b64 s[74:75], vcc
  ds_write_b128 v29, v[196:199] offset:59136
  s_mov_b64 exec, s[74:75]
  v_mov_b32 v200, 2147483711
  v_mov_b32 v201, 2147483648
  v_mov_b32 v202, 2147483711
  v_mov_b32 v203, 2147483648
  ds_write_b128 v29, v[200:203]
  ds_write_b128 v29, v[200:203] offset:8192
  v_cmp_gt_u32 vcc, 112, v0
  s_and_saveexec_b64 s[74:75], vcc
  ds_write_b128 v29, v[200:203] offset:16384
  s_mov_b64 exec, s[74:75]
  s_mul_i32 s100, s2, 16000
  s_lshl_b32 s101, s60, 8
  s_lshl_b32 s76, s61, 8
  s_add_u32 s28, s18, 2621440
  s_addc_u32 s29, s19, 0
  s_add_u32 s28, s28, s100
  s_addc_u32 s29, s29, 0
  s_mov_b32 s30, 16000
  s_mov_b32 s31, 0x20000
  s_mov_b32 s20, s18
  s_mov_b32 s21, s19
  s_mov_b32 s22, 2560256
  s_mov_b32 s23, 0x20000
  s_mov_b32 s24, s6
  s_mov_b32 s25, s7
  s_mov_b32 s26, 10240000
  s_mov_b32 s27, 0x20000
  s_add_u32 s32, s18, 19398656
  s_addc_u32 s33, s19, 0
  s_mov_b32 s34, 106496
  s_mov_b32 s35, 0x20000
  s_mov_b32 s36, s16
  s_mov_b32 s37, s17
  s_add_u32 s36, s36, s101
  s_addc_u32 s37, s37, 0
  s_mov_b32 s38, s76
  s_mov_b32 s39, 0x20000
  s_add_u32 s40, s18, 19529728
  s_addc_u32 s41, s19, 0
  s_mov_b32 s42, 2568000
  s_mov_b32 s43, 0x20000
  v_mov_b32 v28, 1
  v_mov_b32 v38, 0
  v_mov_b32 v39, 0
  v_and_b32 v2, 15, v1
  v_bfe_u32 v3, v1, 4, 1
  v_lshrrev_b32 v4, 4, v1
  v_lshlrev_b32 v4, 2, v4
  v_xor_b32 v4, v2, v4
  v_lshlrev_b32 v10, 4, v4
  v_and_b32 v4, 1, v1
  v_xor_b32 v4, v4, v3
  v_lshlrev_b32 v11, 4, v4
  v_lshrrev_b32 v4, 4, v1
  v_lshlrev_b32 v4, 6, v4
  v_lshrrev_b32 v6, 1, v2
  v_lshl_add_u32 v4, v6, 3, v4
  s_lshl_b32 s100, s3, 8
  v_add_u32 v12, s100, v4
  v_bfe_u32 v4, v1, 2, 1
  v_and_b32 v6, 1, v1
  v_lshl_add_u32 v7, v4, 1, v6
  v_bfe_u32 v8, v1, 3, 2
  v_bfe_u32 v9, v1, 1, 1
  v_lshl_add_u32 v8, v8, 1, v9
  v_lshl_add_u32 v9, v7, 3, v8
  v_lshlrev_b32 v9, 3, v9
  v_add_u32 v13, s100, v9
  v_lshrrev_b32 v9, 5, v1
  v_mul_u32_u24 v16, 1040, v8
  v_lshl_add_u32 v16, v7, 8, v16
  v_lshl_add_u32 v16, v9, 4, v16
  v_add_u32 v16, s62, v16
  v_xor_b32 v17, 1, v6
  v_lshl_add_u32 v17, v17, 7, v16
  v_lshl_add_u32 v16, v6, 7, v16
  v_xor_b32 v18, v9, v6
  v_lshl_add_u32 v18, v8, 1, v18
  v_lshl_add_u32 v18, v7, 4, v18
  v_lshlrev_b32 v18, 4, v18
  s_add_u32 s101, s62, 8320
  v_add_u32 v18, s101, v18
  v_bfe_u32 v7, v1, 4, 1
  v_lshlrev_b32 v7, 4, v7
  v_mov_b32 v8, 0x3f80
  v_lshlrev_b32 v7, v7, v8
  v_cmp_eq_u32 vcc, v9, v4
  s_nop 1
  v_cndmask_b32 v7, 0, v7, vcc
  v_cmp_eq_u32 vcc, 0, v6
  s_nop 1
  v_cndmask_b32 v40, 0, v7, vcc
  v_cndmask_b32 v41, v7, 0, vcc
  s_lshl_b32 s100, s3, 5
  s_add_u32 s101, s100, 18176
  v_lshlrev_b32 v15, 4, v9
  v_add_u32 v15, s101, v15
  v_and_b32 v4, 12, v1
  v_add_u32 v14, v15, v4
  v_and_b32 v4, 3, v1
  v_lshlrev_b32 v4, 3, v4
  v_lshl_add_u32 v4, v3, 5, v4
  v_add_u32 v23, 62880, v4
  v_and_b32 v4, 31, v1
  v_lshlrev_b32 v6, 3, v4
  v_add_u32 v24, 21280, v6
  v_lshrrev_b32 v6, 4, v1
  v_mul_u32_u24 v25, 288, v2
  v_lshl_add_u32 v25, v6, 4, v25
  v_add_u32 v25, 75680, v25
  v_mul_u32_u24 v26, 320, v2
  v_lshl_add_u32 v26, v6, 3, v26
  s_add_u32 s101, s100, 62880
  v_add_u32 v26, s101, v26
  v_mul_u32_u24 v32, 2176, v6
  v_bfe_u32 v7, v1, 2, 2
  v_lshl_add_u32 v32, v7, 8, v32
  v_xor_b32 v7, s3, v7
  v_lshl_add_u32 v32, v7, 5, v32
  v_and_b32 v7, 3, v1
  v_lshl_add_u32 v32, v7, 3, v32
  v_add_u32 v32, 122016, v32
  v_and_b32 v6, 1, v1
  v_lshlrev_b32 v6, 4, v6
  v_lshlrev_b32 v6, v6, v8
  v_bfe_u32 v7, v1, 1, 4
  v_lshlrev_b32 v9, 2, v9
  v_sub_u32 v7, v7, v9
  v_bfe_u32 v6, v1, 4, 1
  v_bfe_u32 v7, v1, 1, 1
  v_lshl_add_u32 v6, v6, 1, v7
  v_bfe_u32 v7, v1, 3, 1
  v_lshrrev_b32 v9, 5, v1
  v_xor_b32 v7, v7, v9
  v_lshl_add_u32 v6, v7, 2, v6
  v_cmp_eq_u32 vcc, 0, v6
  s_nop 1
  v_cndmask_b32 v54, 0, v8, vcc
  v_cmp_eq_u32 vcc, 1, v6
  s_nop 1
  v_cndmask_b32 v55, 0, v8, vcc
  v_cmp_eq_u32 vcc, 2, v6
  s_nop 1
  v_cndmask_b32 v56, 0, v8, vcc
  v_cmp_eq_u32 vcc, 3, v6
  s_nop 1
  v_cndmask_b32 v57, 0, v8, vcc
  v_bfe_u32 v6, v1, 2, 1
  v_and_b32 v7, 1, v1
  v_lshl_add_u32 v6, v6, 1, v7
  v_mul_u32_u24 v58, 0x5555, v6
  v_bfe_u32 v6, v1, 2, 2
  v_mul_u32_u24 v7, 4160, v9
  v_lshl_add_u32 v7, v6, 8, v7
  v_subrev_u32 v9, 62880, v23
  v_add3_u32 v7, v7, v9, s62
  v_xor_b32 v9, 0, v6
  v_lshl_add_u32 v19, v9, 6, v7
  v_xor_b32 v9, 1, v6
  v_lshl_add_u32 v20, v9, 6, v7
  v_xor_b32 v9, 2, v6
  v_lshl_add_u32 v21, v9, 6, v7
  v_xor_b32 v9, 3, v6
  v_lshl_add_u32 v22, v9, 6, v7
  s_cmp_lt_u32 s3, 2
  s_cselect_b32 s73, -1, 0
  s_lshr_b32 s100, s2, 4
  s_lshl_b32 s100, s100, 8
  s_bfe_u32 s101, s2, 0x30001
  s_lshl_b32 s101, s101, 2
  s_add_u32 s100, s100, s101
  s_and_b32 s101, s2, 1
  s_mul_i32 s101, s101, 32768
  s_add_u32 s100, s100, s101
  v_mul_u32_u24 v34, 4096, v1
  v_add_u32 v34, s100, v34
  v_lshrrev_b32 v4, 2, v1
  v_lshlrev_b32 v4, 8, v4
  v_and_b32 v5, 3, v1
  v_lshl_add_u32 v4, v5, 3, v4
  v_add_u32 v33, s71, v4
  s_mov_b32 s76, 3216550459
  s_mov_b32 s77, 3216550459
  s_waitcnt lgkmcnt(0)
  s_add_u32 s70, s70, 1
  s_max_u32 s70, s70, 1
  s_bitcmp1_b32 s2, 0
  s_cbranch_scc1 K_GEMM
  s_cmp_ge_u32 s2, 250
  s_cbranch_scc1 K_PREP
  s_mov_b32 s100, 26843
  v_lshlrev_b32 v9, 6, v0
  v_add_u32 v9, 262144, v9
  s_barrier
  s_waitcnt vmcnt(5)
  v_mul_u32_u24 v132, s100, v122
  v_lshrrev_b32 v132, 18, v132
  v_and_b32 v132, 0x3fc, v132
  v_add_u32 v2, 119968, v132
  ds_add_rtn_u32 v137, v2, v28
  v_mul_u32_u24 v133, s100, v123
  v_lshrrev_b32 v133, 18, v133
  v_and_b32 v133, 0x3fc, v133
  v_add_u32 v3, 119968, v133
  ds_add_rtn_u32 v138, v3, v28
  v_mul_u32_u24 v134, s100, v124
  v_lshrrev_b32 v134, 18, v134
  v_and_b32 v134, 0x3fc, v134
  v_add_u32 v4, 119968, v134
  ds_add_rtn_u32 v139, v4, v28
  v_mul_u32_u24 v135, s100, v125
  v_lshrrev_b32 v135, 18, v135
  v_and_b32 v135, 0x3fc, v135
  v_add_u32 v5, 119968, v135
  ds_add_rtn_u32 v140, v5, v28
  v_mul_u32_u24 v136, s100, v126
  v_lshrrev_b32 v136, 18, v136
  v_and_b32 v136, 0x3fc, v136
  v_add_u32 v6, 119968, v136
  ds_add_rtn_u32 v141, v6, v28
  s_waitcnt vmcnt(0)
  v_lshl_add_u32 v127, v127, 18, v9
  v_and_or_b32 v127, v122, 63, v127
  v_lshlrev_b32 v142, 5, v132
  v_add_u32 v142, 87200, v142
  v_add_u32 v9, 32768, v9
  v_lshl_add_u32 v128, v128, 18, v9
  v_and_or_b32 v128, v123, 63, v128
  v_lshlrev_b32 v143, 5, v133
  v_add_u32 v143, 87200, v143
  v_add_u32 v9, 32768, v9
  v_lshl_add_u32 v129, v129, 18, v9
  v_and_or_b32 v129, v124, 63, v129
  v_lshlrev_b32 v144, 5, v134
  v_add_u32 v144, 87200, v144
  v_add_u32 v9, 32768, v9
  v_lshl_add_u32 v130, v130, 18, v9
  v_and_or_b32 v130, v125, 63, v130
  v_lshlrev_b32 v145, 5, v135
  v_add_u32 v145, 87200, v145
  v_add_u32 v9, 32768, v9
  v_lshl_add_u32 v131, v131, 18, v9
  v_and_or_b32 v131, v126, 63, v131
  v_lshlrev_b32 v146, 5, v136
  v_add_u32 v146, 87200, v146
  s_add_u32 s56, s18, 2621440
  s_addc_u32 s57, s19, 0
  s_mov_b32 s58, 4096000
  s_mov_b32 s59, 0x20000
  v_lshrrev_b32 v6, 3, v0
  s_mov_b32 s100, 16000
  v_mul_u32_u24 v6, s100, v6
  v_and_b32 v7, 7, v0
  v_lshl_add_u32 v6, v7, 4, v6
  s_lshl_b32 s100, s2, 6
  s_mov_b64 s[78:79], 0
  s_waitcnt lgkmcnt(0)
  v_mul_u32_u24 v3, 37, v137
  v_lshl_add_u32 v2, v137, 2, v142
  v_lshrrev_b32 v3, 8, v3
  v_cmp_le_u32 vcc, 28, v137
  v_lshl_add_u32 v2, v3, 2, v2
  s_or_b64 s[78:79], s[78:79], vcc
  s_andn2_b64 exec, exec, vcc
  ds_write_b32 v2, v127
  s_mov_b64 exec, -1
  v_mul_u32_u24 v3, 37, v138
  v_lshl_add_u32 v2, v138, 2, v143
  v_lshrrev_b32 v3, 8, v3
  v_cmp_le_u32 vcc, 28, v138
  v_lshl_add_u32 v2, v3, 2, v2
  s_or_b64 s[78:79], s[78:79], vcc
  s_andn2_b64 exec, exec, vcc
  ds_write_b32 v2, v128
  s_mov_b64 exec, -1
  v_mul_u32_u24 v3, 37, v139
  v_lshl_add_u32 v2, v139, 2, v144
  v_lshrrev_b32 v3, 8, v3
  v_cmp_le_u32 vcc, 28, v139
  v_lshl_add_u32 v2, v3, 2, v2
  s_or_b64 s[78:79], s[78:79], vcc
  s_andn2_b64 exec, exec, vcc
  ds_write_b32 v2, v129
  s_mov_b64 exec, -1
  v_mul_u32_u24 v3, 37, v140
  v_lshl_add_u32 v2, v140, 2, v145
  v_lshrrev_b32 v3, 8, v3
  v_cmp_le_u32 vcc, 28, v140
  v_lshl_add_u32 v2, v3, 2, v2
  s_or_b64 s[78:79], s[78:79], vcc
  s_andn2_b64 exec, exec, vcc
  ds_write_b32 v2, v130
  s_mov_b64 exec, -1
  v_mul_u32_u24 v3, 37, v141
  v_lshl_add_u32 v2, v141, 2, v146
  v_lshrrev_b32 v3, 8, v3
  v_cmp_le_u32 vcc, 28, v141
  v_lshl_add_u32 v2, v3, 2, v2
  s_or_b64 s[78:79], s[78:79], vcc
  s_andn2_b64 exec, exec, vcc
  ds_write_b32 v2, v131
  s_mov_b64 exec, -1
  v_add_u32 v2, 87200, v29
  v_mov_b32 v4, 21220
  s_cmp_eq_u64 s[78:79], 0
  s_cbranch_scc1 K_NOFULL
  ds_write_b32 v4, v28
K_NOFULL:
  s_waitcnt lgkmcnt(0)
  s_barrier
  ds_read_b32 v4, v4
K_OVFDONE:
  ds_read_b128 v[90:93], v2 offset:0
  ds_read_b128 v[94:97], v2 offset:8192
  ds_read_b128 v[98:101], v2 offset:16384
  ds_read_b128 v[102:105], v2 offset:24576
  s_waitcnt vmcnt(63) lgkmcnt(4)
  v_cmp_ne_u32 vcc, 0, v4
  s_cbranch_vccnz K_OVF
  s_mov_b32 exec_lo, 0xaaaaaaaa
  s_mov_b32 exec_hi, 0xaaaaaaaa
  s_waitcnt lgkmcnt(3)
  v_mov_b32 v93, s70
  s_mov_b64 exec, -1
  buffer_store_dwordx4 v[90:93], v6, s[56:59], s100 offen sc1
  s_mov_b64 exec, -1
  s_add_u32 s100, s100, 1024000
  s_mov_b32 exec_lo, 0xaaaaaaaa
  s_mov_b32 exec_hi, 0xaaaaaaaa
  s_waitcnt lgkmcnt(2)
  v_mov_b32 v97, s70
  s_mov_b64 exec, -1
  buffer_store_dwordx4 v[94:97], v6, s[56:59], s100 offen sc1
  s_mov_b64 exec, -1
  s_add_u32 s100, s100, 1024000
  s_mov_b32 exec_lo, 0xaaaaaaaa
  s_mov_b32 exec_hi, 0xaaaaaaaa
  s_waitcnt lgkmcnt(1)
  v_mov_b32 v101, s70
  s_mov_b64 exec, -1
  buffer_store_dwordx4 v[98:101], v6, s[56:59], s100 offen sc1
  s_mov_b64 exec, -1
  s_add_u32 s100, s100, 1024000
  s_mov_b32 exec_lo, 0xaaaaaaaa
  s_mov_b32 exec_hi, 0xaaaaaaaa
  s_waitcnt lgkmcnt(0)
  v_mov_b32 v105, s70
  s_mov_b64 exec, -1
  buffer_store_dwordx4 v[102:105], v6, s[56:59], s100 offen sc1
  s_mov_b64 exec, -1
  s_add_u32 s100, s100, 1024000
  s_lshl_b32 s100, s60, 8
  s_lshl_b32 s101, s61, 8
  s_mov_b32 s56, s4
  s_mov_b32 s57, s5
  s_add_u32 s56, s56, s100
  s_addc_u32 s57, s57, 0
  s_mov_b32 s58, s101
  s_mov_b32 s59, 0x20000
  v_add_u32 v8, 8192, v29
  buffer_load_dwordx4 v[204:207], v29, s[56:59], 0 offen
  buffer_load_dwordx4 v[208:211], v8, s[56:59], 0 offen
  v_lshrrev_b32 v2, 4, v0
  v_lshl_add_u32 v2, v2, 5, v29
  v_add_u32 v2, 75680, v2
  s_waitcnt vmcnt(0)
  ds_write_b128 v2, v[204:207]
  s_mov_b32 exec_lo, s73
  s_mov_b32 exec_hi, s73
  ds_write_b128 v2, v[208:211] offset:9216
  s_mov_b64 exec, -1
  s_branch K_PST
K_GW:
  s_branch K_PST
K_GEMM:
  s_mul_i32 s100, s79, 288
  s_sub_u32 s100, 75680, s100
  v_lshrrev_b32 v2, 4, v0
  v_lshl_add_u32 v2, v2, 5, v29
  v_add_u32 v5, s100, v2
  s_cmp_lt_u32 s3, 4
  s_cselect_b32 s101, -1, 0
  v_subrev_u32 v3, 75680, v25
  v_add_u32 v3, s100, v3
  s_waitcnt vmcnt(6)
  ds_write_b128 v5, v[62:65]
  s_waitcnt vmcnt(5)
  ds_write_b128 v5, v[66:69] offset:9216
  s_waitcnt vmcnt(4)
  s_mov_b32 exec_lo, s101
  s_mov_b32 exec_hi, s101
  ds_write_b128 v5, v[70:73] offset:18432
  s_mov_b64 exec, -1
  v_and_b32 v4, 15, v1
  v_mul_u32_u24 v4, 288, v4
  v_lshrrev_b32 v5, 4, v1
  v_lshl_add_u32 v4, v5, 3, v4
  s_lshl_b32 s100, s3, 5
  s_add_u32 s100, s100, 88224
  v_add_u32 v4, s100, v4
  v_add_u32 v2, 83616, v2
  v_subrev_u32 v6, 4096, v29
  s_add_u32 s48, s18, 256
  s_addc_u32 s49, s19, 0
  s_add_u32 s48, s48, s64
  s_addc_u32 s49, s49, 0
  s_mov_b32 s50, s63
  s_mov_b32 s51, 0x20000
  s_waitcnt vmcnt(0) lgkmcnt(0)
  s_barrier
  ds_read_b64_tr_b16 v[216:217], v32 offset:0
  ds_read_b64_tr_b16 v[218:219], v32 offset:1088
  ds_read_b64_tr_b16 v[220:221], v32 offset:8704
  ds_read_b64_tr_b16 v[222:223], v32 offset:9792
  ds_read_b64_tr_b16 v[224:225], v32 offset:17408
  ds_read_b64_tr_b16 v[226:227], v32 offset:18496
  ds_read_b64_tr_b16 v[228:229], v32 offset:26112
  ds_read_b64_tr_b16 v[230:231], v32 offset:27200
  ds_read_b128 v[90:93], v3 offset:0
  ds_read_b128 v[94:97], v3 offset:64
  ds_read_b128 v[98:101], v3 offset:128
  ds_read_b128 v[102:105], v3 offset:192
  ds_read_b128 v[106:109], v3 offset:4608
  ds_read_b128 v[110:113], v3 offset:4672
  ds_read_b128 v[114:117], v3 offset:4736
  ds_read_b128 v[118:121], v3 offset:4800
  ds_read_b128 v[156:159], v3 offset:9216
  ds_read_b128 v[160:163], v3 offset:9280
  ds_read_b128 v[164:167], v3 offset:9344
  ds_read_b128 v[168:171], v3 offset:9408
  ds_read_b128 v[172:175], v3 offset:13824
  ds_read_b128 v[176:179], v3 offset:13888
  ds_read_b128 v[180:183], v3 offset:13952
  ds_read_b128 v[184:187], v3 offset:14016
  s_waitcnt lgkmcnt(12)
  v_mfma_f32_16x16x32_bf16 v[122:125], v[216:219], v[90:93], 0
  v_mfma_f32_16x16x32_bf16 v[122:125], v[220:223], v[94:97], v[122:125]
  v_mfma_f32_16x16x32_bf16 v[122:125], v[224:227], v[98:101], v[122:125]
  v_mfma_f32_16x16x32_bf16 v[122:125], v[228:231], v[102:105], v[122:125]
  ds_read_b128 v[90:93], v3 offset:18432
  ds_read_b128 v[94:97], v3 offset:18496
  ds_read_b128 v[98:101], v3 offset:18560
  ds_read_b128 v[102:105], v3 offset:18624
  s_waitcnt lgkmcnt(12)
  v_mfma_f32_16x16x32_bf16 v[126:129], v[216:219], v[106:109], 0
  v_mfma_f32_16x16x32_bf16 v[126:129], v[220:223], v[110:113], v[126:129]
  v_mfma_f32_16x16x32_bf16 v[126:129], v[224:227], v[114:117], v[126:129]
  v_mfma_f32_16x16x32_bf16 v[126:129], v[228:231], v[118:121], v[126:129]
  s_waitcnt lgkmcnt(8)
  v_mfma_f32_16x16x32_bf16 v[130:133], v[216:219], v[156:159], 0
  v_mfma_f32_16x16x32_bf16 v[130:133], v[220:223], v[160:163], v[130:133]
  v_mfma_f32_16x16x32_bf16 v[130:133], v[224:227], v[164:167], v[130:133]
  v_mfma_f32_16x16x32_bf16 v[130:133], v[228:231], v[168:171], v[130:133]
  s_waitcnt lgkmcnt(4)
  v_mfma_f32_16x16x32_bf16 v[134:137], v[216:219], v[172:175], 0
  v_mfma_f32_16x16x32_bf16 v[134:137], v[220:223], v[176:179], v[134:137]
  v_mfma_f32_16x16x32_bf16 v[134:137], v[224:227], v[180:183], v[134:137]
  v_mfma_f32_16x16x32_bf16 v[134:137], v[228:231], v[184:187], v[134:137]
  s_waitcnt lgkmcnt(0)
  v_mfma_f32_16x16x32_bf16 v[138:141], v[216:219], v[90:93], 0
  v_mfma_f32_16x16x32_bf16 v[138:141], v[220:223], v[94:97], v[138:141]
  v_mfma_f32_16x16x32_bf16 v[138:141], v[224:227], v[98:101], v[138:141]
  v_mfma_f32_16x16x32_bf16 v[138:141], v[228:231], v[102:105], v[138:141]
  v_pk_mul_f32 v[122:123], v[122:123], s[76:77]
  v_pk_mul_f32 v[124:125], v[124:125], s[76:77]
  v_cvt_pk_bf16_f32 v62, v122, v123
  v_cvt_pk_bf16_f32 v63, v124, v125
  ds_write_b64 v4, v[62:63] offset:0
  v_pk_mul_f32 v[126:127], v[126:127], s[76:77]
  v_pk_mul_f32 v[128:129], v[128:129], s[76:77]
  v_cvt_pk_bf16_f32 v64, v126, v127
  v_cvt_pk_bf16_f32 v65, v128, v129
  ds_write_b64 v4, v[64:65] offset:4608
  v_pk_mul_f32 v[130:131], v[130:131], s[76:77]
  v_pk_mul_f32 v[132:133], v[132:133], s[76:77]
  v_cvt_pk_bf16_f32 v66, v130, v131
  v_cvt_pk_bf16_f32 v67, v132, v133
  ds_write_b64 v4, v[66:67] offset:9216
  v_pk_mul_f32 v[134:135], v[134:135], s[76:77]
  v_pk_mul_f32 v[136:137], v[136:137], s[76:77]
  v_cvt_pk_bf16_f32 v68, v134, v135
  v_cvt_pk_bf16_f32 v69, v136, v137
  ds_write_b64 v4, v[68:69] offset:13824
  s_nop 1
  v_pk_mul_f32 v[138:139], v[138:139], s[76:77]
  v_pk_mul_f32 v[140:141], v[140:141], s[76:77]
  v_cvt_pk_bf16_f32 v70, v138, v139
  v_cvt_pk_bf16_f32 v71, v140, v141
  ds_write_b64 v4, v[70:71] offset:18432
  s_waitcnt vmcnt(0) lgkmcnt(0)
  s_barrier
  s_cmp_lt_u32 s3, 4
  s_cbranch_scc1 K_GW
  ds_read_b128 v[90:93], v2 offset:0
  ds_read_b128 v[94:97], v2 offset:4608
  ds_read_b128 v[98:101], v2 offset:9216
  ds_read_b128 v[102:105], v2 offset:13824
  ds_read_b128 v[106:109], v2 offset:18432
  s_waitcnt lgkmcnt(4)
  buffer_store_dwordx4 v[90:93], v6, s[48:51], 0 offen sc1
  v_add_u32 v6, 4096, v6
  s_waitcnt lgkmcnt(3)
  buffer_store_dwordx4 v[94:97], v6, s[48:51], 0 offen sc1
  v_add_u32 v6, 4096, v6
  s_waitcnt lgkmcnt(2)
  buffer_store_dwordx4 v[98:101], v6, s[48:51], 0 offen sc1
  v_add_u32 v6, 4096, v6
  s_waitcnt lgkmcnt(1)
  buffer_store_dwordx4 v[102:105], v6, s[48:51], 0 offen sc1
  v_add_u32 v6, 4096, v6
  s_waitcnt lgkmcnt(0)
  buffer_store_dwordx4 v[106:109], v6, s[48:51], 0 offen sc1
  v_mov_b32 v2, 21228
  v_mov_b32 v9, s70
  s_waitcnt vmcnt(3)
  v_min_u32 v6, 2, v1
  s_lshl_b32 s100, s2, 7
  v_lshl_add_u32 v6, v6, 2, s100
  buffer_load_dwordx4 v[122:125], v30, s[28:31], 0 offen sc1
  buffer_load_dwordx4 v[126:129], v30, s[28:31], 0 offen offset:64 sc1
  s_mov_b32 s66, 9
  s_mov_b64 exec, 1
  s_waitcnt vmcnt(2)
  ds_add_rtn_u32 v2, v2, v28
  s_waitcnt lgkmcnt(0)
  v_readfirstlane_b32 s53, v2
  s_mov_b64 exec, -1
  s_cmp_lg_u32 s53, 3
  s_cbranch_scc1 K_PST
K_FLAG:
  s_mov_b64 exec, 0xff
  buffer_store_dword v9, v34, s[44:47], 0 offen sc1
  s_mov_b64 exec, -1
K_PST:
  s_lshl_b32 s4, s3, 12
  s_add_u32 s5, s4, 32768
  s_add_u32 s72, s4, 65536
  s_mov_b32 s6, 98304
  s_mov_b32 s7, 102400
  s_mov_b32 s48, 2863311530
  s_cmp_eq_u32 s3, 7
  s_cselect_b32 s49, 699050, s48
  v_min_u32 v6, 2, v1
  s_lshl_b32 s100, s2, 7
  v_lshl_add_u32 v6, v6, 2, s100
  s_mov_b32 s100, 0
  v_lshlrev_b32 v31, 4, v1
  s_mov_b32 s54, 0
  v_mov_b32 v237, 0
  s_cmp_eq_u32 s66, 9
  s_mov_b32 s66, 0
  s_cbranch_scc1 K_CPOLLW
K_CPOLL:
  buffer_load_dwordx4 v[122:125], v30, s[28:31], 0 offen sc1
  buffer_load_dwordx4 v[126:129], v30, s[28:31], 0 offen offset:64 sc1
  s_add_u32 s100, s100, 1
  s_waitcnt vmcnt(0)
K_CPOLLC:
  v_cmp_ne_u32 vcc, s70, v125
  v_cmp_ne_u32 s[78:79], s70, v129
  s_or_b64 s[78:79], vcc, s[78:79]
  s_mov_b64 s[50:51], -1
  s_and_b64 s[78:79], s[78:79], s[48:49]
  s_cbranch_scc1 K_CAGAIN
K_CPOLLD:
  v_mov_b32 v238, v6
  buffer_load_dword v237, v6, s[44:47], 0 offen sc1
  s_mov_b32 exec_lo, 0xaaaaaaaa
  s_mov_b32 exec_hi, 0xaaaaaaaa
  v_mov_b32 v125, 0
  v_mov_b32 v129, 0
  s_mov_b64 exec, -1
K_PHASE1:
  v_cmp_le_u32 vcc, 0xfffc0000, v128
  s_cbranch_vccnz K_MARK
K_NOMARK:
  v_lshlrev_b32 v130, 2, v122
  v_and_b32 v130, 0xfc, v130
  v_cmpx_ne_u32 vcc, 0, v122
  ds_add_rtn_u32 v138, v130, v28 offset:20960
  s_mov_b64 exec, -1
  v_lshlrev_b32 v131, 2, v123
  v_and_b32 v131, 0xfc, v131
  v_cmpx_ne_u32 vcc, 0, v123
  ds_add_rtn_u32 v139, v131, v28 offset:20960
  s_mov_b64 exec, -1
  v_lshlrev_b32 v132, 2, v124
  v_and_b32 v132, 0xfc, v132
  v_cmpx_ne_u32 vcc, 0, v124
  ds_add_rtn_u32 v140, v132, v28 offset:20960
  s_mov_b64 exec, -1
  v_lshlrev_b32 v133, 2, v125
  v_and_b32 v133, 0xfc, v133
  v_cmpx_ne_u32 vcc, 0, v125
  ds_add_rtn_u32 v141, v133, v28 offset:20960
  s_mov_b64 exec, -1
  v_or3_b32 v5, v126, v127, v128
  v_or_b32 v5, v5, v129
  v_cmp_ne_u32 vcc, 0, v5
  s_cbranch_vccz K_P1E
  v_lshlrev_b32 v134, 2, v126
  v_and_b32 v134, 0xfc, v134
  v_cmpx_ne_u32 vcc, 0, v126
  ds_add_rtn_u32 v142, v134, v28 offset:20960
  s_mov_b64 exec, -1
  v_lshlrev_b32 v135, 2, v127
  v_and_b32 v135, 0xfc, v135
  v_cmpx_ne_u32 vcc, 0, v127
  ds_add_rtn_u32 v143, v135, v28 offset:20960
  s_mov_b64 exec, -1
  v_lshlrev_b32 v136, 2, v128
  v_and_b32 v136, 0xfc, v136
  v_cmpx_ne_u32 vcc, 0, v128
  ds_add_rtn_u32 v144, v136, v28 offset:20960
  s_mov_b64 exec, -1
  v_lshlrev_b32 v137, 2, v129
  v_and_b32 v137, 0xfc, v137
  v_cmpx_ne_u32 vcc, 0, v129
  ds_add_rtn_u32 v145, v137, v28 offset:20960
  s_mov_b64 exec, -1
K_P1E:
  s_cmp_lg_u32 s54, 0
  s_cbranch_scc1 K_NOWL
  s_cmp_lg_u64 s[50:51], 0
  s_cbranch_scc1 K_NOWL
  s_mov_b32 s54, 1
  buffer_load_dwordx4 v[156:159], v31, s[32:35], s4 offen offset:0 sc1
  buffer_load_dwordx4 v[160:163], v31, s[32:35], s4 offen offset:1024 sc1
  buffer_load_dwordx4 v[164:167], v31, s[32:35], s4 offen offset:2048 sc1
  buffer_load_dwordx4 v[168:171], v31, s[32:35], s4 offen offset:3072 sc1
  buffer_load_dwordx4 v[172:175], v31, s[32:35], s5 offen offset:0 sc1
  buffer_load_dwordx4 v[176:179], v31, s[32:35], s5 offen offset:1024 sc1
  buffer_load_dwordx4 v[180:183], v31, s[32:35], s5 offen offset:2048 sc1
  buffer_load_dwordx4 v[184:187], v31, s[32:35], s5 offen offset:3072 sc1
  buffer_load_dwordx4 v[62:65], v31, s[32:35], s6 offen offset:0 sc1
  buffer_load_dwordx4 v[66:69], v31, s[32:35], s6 offen offset:1024 sc1
  buffer_load_dwordx4 v[70:73], v31, s[32:35], s6 offen offset:2048 sc1
  buffer_load_dwordx4 v[74:77], v31, s[32:35], s6 offen offset:3072 sc1
K_NOWL:
  v_lshlrev_b32 v2, 2, v1
  v_subrev_u32 v6, s60, v1
  v_and_b32 v6, 63, v6
  s_waitcnt lgkmcnt(0)
  s_barrier
  ds_read_b32 v3, v2 offset:20960
  s_waitcnt lgkmcnt(0)
  v_add_u32 v3, 3, v3
  v_bfe_u32 v7, v3, 2, 1
  v_lshrrev_b32 v8, 3, v3
  v_lshl_or_b32 v3, v7, 16, v8
  v_mov_b32 v4, v3
  s_nop 1
  v_add_u32_dpp v4, v4, v4 row_shr:1 row_mask:0xf bank_mask:0xf
  s_nop 1
  v_add_u32_dpp v4, v4, v4 row_shr:2 row_mask:0xf bank_mask:0xf
  s_nop 1
  v_add_u32_dpp v4, v4, v4 row_shr:4 row_mask:0xf bank_mask:0xf
  s_nop 1
  v_add_u32_dpp v4, v4, v4 row_shr:8 row_mask:0xf bank_mask:0xf
  s_nop 1
  v_add_u32_dpp v4, v4, v4 row_bcast:15 row_mask:0xa bank_mask:0xf
  s_nop 1
  v_add_u32_dpp v4, v4, v4 row_bcast:31 row_mask:0xc bank_mask:0xf
  s_nop 1
  v_readlane_b32 s64, v4, 63
  v_sub_u32 v3, v4, v3
  s_lshr_b32 s101, s64, 16
  s_and_b32 s59, s64, 0xffff
  s_lshl_b32 s100, s59, 1
  s_lshr_b32 s59, s59, 2
  s_add_u32 s64, s100, s101
  s_add_u32 s64, s64, 7
  s_lshr_b32 s64, s64, 3
  v_lshrrev_b32 v4, 16, v3
  v_add_u32 v4, s100, v4
  v_and_b32 v3, 0xffff, v3
  v_lshl_or_b32 v2, v8, 16, v3
  v_lshlrev_b32 v2, 3, v2
  v_lshlrev_b32 v9, 1, v8
  v_sub_u32 v9, v4, v9
  v_lshlrev_b32 v9, 2, v9
  s_cmp_gt_u32 s64, 70
  s_cbranch_scc1 K_SPLIT
  ds_bpermute_b32 v106, v130, v9
  ds_bpermute_b32 v130, v130, v2
  ds_bpermute_b32 v107, v131, v9
  ds_bpermute_b32 v131, v131, v2
  ds_bpermute_b32 v108, v132, v9
  ds_bpermute_b32 v132, v132, v2
  ds_bpermute_b32 v109, v133, v9
  ds_bpermute_b32 v133, v133, v2
  v_or3_b32 v5, v126, v127, v128
  v_or_b32 v5, v5, v129
  v_cmp_ne_u32 s[56:57], 0, v5
  s_cmp_eq_u64 s[56:57], 0
  s_cbranch_scc1 K_P2A
  ds_bpermute_b32 v110, v134, v9
  ds_bpermute_b32 v134, v134, v2
  ds_bpermute_b32 v111, v135, v9
  ds_bpermute_b32 v135, v135, v2
  ds_bpermute_b32 v112, v136, v9
  ds_bpermute_b32 v136, v136, v2
  ds_bpermute_b32 v113, v137, v9
  ds_bpermute_b32 v137, v137, v2
  v_lshrrev_b32 v98, 10, v126
  v_and_b32 v98, 0xffffff00, v98
  v_bfe_u32 v99, v126, 6, 12
  v_lshl_add_u32 v99, v99, 5, v27
  v_lshrrev_b32 v100, 10, v127
  v_and_b32 v100, 0xffffff00, v100
  v_bfe_u32 v101, v127, 6, 12
  v_lshl_add_u32 v101, v101, 5, v27
  v_lshrrev_b32 v102, 10, v128
  v_and_b32 v102, 0xffffff00, v102
  v_bfe_u32 v103, v128, 6, 12
  v_lshl_add_u32 v103, v103, 5, v27
  v_lshrrev_b32 v104, 10, v129
  v_and_b32 v104, 0xffffff00, v104
  v_bfe_u32 v105, v129, 6, 12
  v_lshl_add_u32 v105, v105, 5, v27
K_P2A:
  s_cmp_lg_u32 s54, 0
  s_cbranch_scc1 K_S0A
  s_waitcnt vmcnt(0)
  v_cmp_ne_u32 vcc, s70, v237
  s_cbranch_vccnz K_S0AX
  s_mov_b32 s54, 1
  buffer_load_dwordx4 v[156:159], v31, s[32:35], s4 offen offset:0 sc1
  buffer_load_dwordx4 v[160:163], v31, s[32:35], s4 offen offset:1024 sc1
  buffer_load_dwordx4 v[164:167], v31, s[32:35], s4 offen offset:2048 sc1
  buffer_load_dwordx4 v[168:171], v31, s[32:35], s4 offen offset:3072 sc1
  buffer_load_dwordx4 v[172:175], v31, s[32:35], s5 offen offset:0 sc1
  buffer_load_dwordx4 v[176:179], v31, s[32:35], s5 offen offset:1024 sc1
  buffer_load_dwordx4 v[180:183], v31, s[32:35], s5 offen offset:2048 sc1
  buffer_load_dwordx4 v[184:187], v31, s[32:35], s5 offen offset:3072 sc1
  buffer_load_dwordx4 v[62:65], v31, s[32:35], s6 offen offset:0 sc1
  buffer_load_dwordx4 v[66:69], v31, s[32:35], s6 offen offset:1024 sc1
  buffer_load_dwordx4 v[70:73], v31, s[32:35], s6 offen offset:2048 sc1
  buffer_load_dwordx4 v[74:77], v31, s[32:35], s6 offen offset:3072 sc1
K_S0A:
  v_lshrrev_b32 v90, 10, v122
  v_and_b32 v90, 0xffffff00, v90
  v_bfe_u32 v91, v122, 6, 12
  v_lshl_add_u32 v91, v91, 5, v27
  v_lshrrev_b32 v92, 10, v123
  v_and_b32 v92, 0xffffff00, v92
  v_bfe_u32 v93, v123, 6, 12
  v_lshl_add_u32 v93, v93, 5, v27
  v_lshrrev_b32 v94, 10, v124
  v_and_b32 v94, 0xffffff00, v94
  v_bfe_u32 v95, v124, 6, 12
  v_lshl_add_u32 v95, v95, 5, v27
  v_lshrrev_b32 v96, 10, v125
  v_and_b32 v96, 0xffffff00, v96
  v_bfe_u32 v97, v125, 6, 12
  v_lshl_add_u32 v97, v97, 5, v27
  v_lshlrev_b32 v4, 2, v4
  v_add_lshl_u32 v5, v3, v8, 3
  v_lshl_add_u32 v3, v3, 1, s3
  v_lshlrev_b32 v3, 2, v3
  s_waitcnt lgkmcnt(0)
  v_cmp_lt_u32_sdwa s[8:9], v138, v130 src0_sel:DWORD src1_sel:WORD_1
  v_cmp_lt_u32_sdwa s[10:11], v139, v131 src0_sel:DWORD src1_sel:WORD_1
  v_cmp_lt_u32_sdwa s[12:13], v140, v132 src0_sel:DWORD src1_sel:WORD_1
  v_cmp_lt_u32_sdwa s[14:15], v141, v133 src0_sel:DWORD src1_sel:WORD_1
  v_and_b32 v130, 0xffff, v130
  v_and_b32 v131, 0xffff, v131
  v_and_b32 v132, 0xffff, v132
  v_and_b32 v133, 0xffff, v133
  v_cndmask_b32 v130, v106, v130, s[8:9]
  v_cndmask_b32 v131, v107, v131, s[10:11]
  v_cndmask_b32 v132, v108, v132, s[12:13]
  v_cndmask_b32 v133, v109, v133, s[14:15]
  v_add_lshl_u32 v130, v130, v138, 3
  v_cmpx_ne_u32 vcc, 0, v122
  ds_write_b64 v130, v[90:91]
  s_mov_b64 exec, -1
  v_add_lshl_u32 v131, v131, v139, 3
  v_cmpx_ne_u32 vcc, 0, v123
  ds_write_b64 v131, v[92:93]
  s_mov_b64 exec, -1
  v_add_lshl_u32 v132, v132, v140, 3
  v_cmpx_ne_u32 vcc, 0, v124
  ds_write_b64 v132, v[94:95]
  s_mov_b64 exec, -1
  v_add_lshl_u32 v133, v133, v141, 3
  v_cmpx_ne_u32 vcc, 0, v125
  ds_write_b64 v133, v[96:97]
  s_mov_b64 exec, -1
  s_cmp_eq_u64 s[56:57], 0
  s_cbranch_scc1 K_P2E
  v_cmp_lt_u32_sdwa s[8:9], v142, v134 src0_sel:DWORD src1_sel:WORD_1
  v_cmp_lt_u32_sdwa s[10:11], v143, v135 src0_sel:DWORD src1_sel:WORD_1
  v_cmp_lt_u32_sdwa s[12:13], v144, v136 src0_sel:DWORD src1_sel:WORD_1
  v_cmp_lt_u32_sdwa s[14:15], v145, v137 src0_sel:DWORD src1_sel:WORD_1
  v_and_b32 v134, 0xffff, v134
  v_and_b32 v135, 0xffff, v135
  v_and_b32 v136, 0xffff, v136
  v_and_b32 v137, 0xffff, v137
  v_cndmask_b32 v134, v110, v134, s[8:9]
  v_cndmask_b32 v135, v111, v135, s[10:11]
  v_cndmask_b32 v136, v112, v136, s[12:13]
  v_cndmask_b32 v137, v113, v137, s[14:15]
  v_add_lshl_u32 v134, v134, v142, 3
  v_cmpx_ne_u32 vcc, 0, v126
  ds_write_b64 v134, v[98:99]
  s_mov_b64 exec, -1
  v_add_lshl_u32 v135, v135, v143, 3
  v_cmpx_ne_u32 vcc, 0, v127
  ds_write_b64 v135, v[100:101]
  s_mov_b64 exec, -1
  v_add_lshl_u32 v136, v136, v144, 3
  v_cmpx_ne_u32 vcc, 0, v128
  ds_write_b64 v136, v[102:103]
  s_mov_b64 exec, -1
  v_add_lshl_u32 v137, v137, v145, 3
  v_cmpx_ne_u32 vcc, 0, v129
  ds_write_b64 v137, v[104:105]
  s_mov_b64 exec, -1
K_P2E:
  v_cmpx_ne_u32 vcc, 0, v7
  ds_write_b32 v4, v6 offset:18176
  s_mov_b64 exec, -1
K_GNL:
  v_cmpx_lt_u32 vcc, v3, v5
  ds_write_b32 v3, v6 offset:18176
  v_add_u32 v3, 32, v3
  v_cmpx_lt_u32 vcc, v3, v5
  ds_write_b32 v3, v6 offset:18176
  v_add_u32 v3, 32, v3
  v_cmpx_lt_u32 vcc, v3, v5
  s_cbranch_execnz K_GNL
  s_mov_b64 exec, -1
  s_add_u32 s63, s64, 7
  s_sub_u32 s63, s63, s3
  s_lshr_b32 s63, s63, 3
  s_add_u32 s59, s59, 7
  s_sub_u32 s59, s59, s3
  s_lshr_b32 s59, s59, 3
  s_cmp_lg_u32 s54, 0
  s_cbranch_scc1 K_S0B
  s_waitcnt vmcnt(0)
  v_cmp_ne_u32 vcc, s70, v237
  s_cbranch_vccnz K_S0BX
  s_mov_b32 s54, 1
  buffer_load_dwordx4 v[156:159], v31, s[32:35], s4 offen offset:0 sc1
  buffer_load_dwordx4 v[160:163], v31, s[32:35], s4 offen offset:1024 sc1
  buffer_load_dwordx4 v[164:167], v31, s[32:35], s4 offen offset:2048 sc1
  buffer_load_dwordx4 v[168:171], v31, s[32:35], s4 offen offset:3072 sc1
  buffer_load_dwordx4 v[172:175], v31, s[32:35], s5 offen offset:0 sc1
  buffer_load_dwordx4 v[176:179], v31, s[32:35], s5 offen offset:1024 sc1
  buffer_load_dwordx4 v[180:183], v31, s[32:35], s5 offen offset:2048 sc1
  buffer_load_dwordx4 v[184:187], v31, s[32:35], s5 offen offset:3072 sc1
  buffer_load_dwordx4 v[62:65], v31, s[32:35], s6 offen offset:0 sc1
  buffer_load_dwordx4 v[66:69], v31, s[32:35], s6 offen offset:1024 sc1
  buffer_load_dwordx4 v[70:73], v31, s[32:35], s6 offen offset:2048 sc1
  buffer_load_dwordx4 v[74:77], v31, s[32:35], s6 offen offset:3072 sc1
K_S0B:
  s_cmp_eq_u32 s67, 0
  s_cbranch_scc1 K_POLL2_D
  s_cmp_lg_u32 s3, 1
  s_cbranch_scc1 K_POLL2_D
  s_mov_b32 s100, 0
  s_mov_b32 s101, 32768
  v_min_u32 v2, 2, v1
  s_lshl_b32 s78, s2, 7
  v_lshl_add_u32 v2, v2, 2, s78
K_POLL2:
  buffer_load_dwordx2 v[232:233], v33, s[44:47], s101 offen sc1
  buffer_load_dword v234, v2, s[44:47], 0 offen sc1
  s_add_u32 s100, s100, 1
  s_waitcnt vmcnt(0)
  v_cmp_ne_u32 vcc, s70, v232
  v_cmp_ne_u32 s[78:79], s70, v233
  s_or_b64 vcc, vcc, s[78:79]
  v_cmp_ne_u32 s[78:79], s70, v234
  s_or_b64 vcc, vcc, s[78:79]
  s_cbranch_scc0 K_POLL2_D
  s_sleep 2
  s_cmp_lt_u32 s100, 0x8000
  s_cbranch_scc1 K_POLL2
K_POLL2_D:
  s_waitcnt lgkmcnt(0)
  s_barrier
  ds_read_b64 v[36:37], v12
  s_waitcnt lgkmcnt(0)
  s_add_u32 m0, s62, 0
  v_add_u32_dpp v52, v36, v10 row_newbcast:0 row_mask:0xf bank_mask:0xf
  buffer_load_dwordx4 v52, s[20:23], 0 offen sc1 lds
  s_add_u32 m0, s62, 1040
  v_add_u32_dpp v53, v36, v10 row_newbcast:2 row_mask:0xf bank_mask:0xf
  buffer_load_dwordx4 v53, s[20:23], 0 offen sc1 lds
  s_add_u32 m0, s62, 2080
  v_add_u32_dpp v52, v36, v10 row_newbcast:4 row_mask:0xf bank_mask:0xf
  buffer_load_dwordx4 v52, s[20:23], 0 offen sc1 lds
  s_add_u32 m0, s62, 3120
  v_add_u32_dpp v53, v36, v10 row_newbcast:6 row_mask:0xf bank_mask:0xf
  buffer_load_dwordx4 v53, s[20:23], 0 offen sc1 lds
  s_add_u32 m0, s62, 4160
  v_add_u32_dpp v52, v36, v10 row_newbcast:8 row_mask:0xf bank_mask:0xf
  buffer_load_dwordx4 v52, s[20:23], 0 offen sc1 lds
  s_add_u32 m0, s62, 5200
  v_add_u32_dpp v53, v36, v10 row_newbcast:10 row_mask:0xf bank_mask:0xf
  buffer_load_dwordx4 v53, s[20:23], 0 offen sc1 lds
  s_add_u32 m0, s62, 6240
  v_add_u32_dpp v52, v36, v10 row_newbcast:12 row_mask:0xf bank_mask:0xf
  buffer_load_dwordx4 v52, s[20:23], 0 offen sc1 lds
  s_add_u32 m0, s62, 7280
  v_add_u32_dpp v53, v36, v10 row_newbcast:14 row_mask:0xf bank_mask:0xf
  buffer_load_dwordx4 v53, s[20:23], 0 offen sc1 lds
  s_add_u32 m0, s62, 8320
  v_add_u32 v52, v37, v11
  buffer_load_dwordx4 v52, s[24:27], 0 offen  lds
  ds_read_b64 v[36:37], v12 offset:2048
  s_cmp_eq_u32 s67, 0
  s_cbranch_scc1 K_NOGEMM0
  s_cmp_eq_u32 s54, 0
  s_cbranch_scc1 K_WLATE
  s_waitcnt vmcnt(9) lgkmcnt(0)
K_WOK:
  s_mov_b32 s67, 0
  ds_read_b128 v[90:93], v25 offset:0
  ds_read_b128 v[94:97], v25 offset:64
  ds_read_b128 v[98:101], v25 offset:128
  ds_read_b128 v[102:105], v25 offset:192
  ds_read_b128 v[106:109], v25 offset:4608
  ds_read_b128 v[110:113], v25 offset:4672
  ds_read_b128 v[114:117], v25 offset:4736
  ds_read_b128 v[118:121], v25 offset:4800
  s_waitcnt lgkmcnt(4)
  v_mfma_f32_16x16x32_bf16 v[196:199], v[156:159], v[90:93], 0
  v_mfma_f32_16x16x32_bf16 v[196:199], v[160:163], v[94:97], v[196:199]
  v_mfma_f32_16x16x32_bf16 v[196:199], v[164:167], v[98:101], v[196:199]
  v_mfma_f32_16x16x32_bf16 v[196:199], v[168:171], v[102:105], v[196:199]
  v_mfma_f32_16x16x32_bf16 v[204:207], v[172:175], v[90:93], 0
  v_mfma_f32_16x16x32_bf16 v[204:207], v[176:179], v[94:97], v[204:207]
  v_mfma_f32_16x16x32_bf16 v[204:207], v[180:183], v[98:101], v[204:207]
  v_mfma_f32_16x16x32_bf16 v[204:207], v[184:187], v[102:105], v[204:207]
  ds_read_b128 v[90:93], v25 offset:9216
  ds_read_b128 v[94:97], v25 offset:9280
  ds_read_b128 v[98:101], v25 offset:9344
  ds_read_b128 v[102:105], v25 offset:9408
  s_nop 7
  v_pk_mul_f32 v[196:197], v[196:197], s[76:77]
  v_pk_mul_f32 v[198:199], v[198:199], s[76:77]
  v_cvt_pk_bf16_f32 v200, v196, v197
  v_cvt_pk_bf16_f32 v201, v198, v199
  ds_write_b64 v26, v[200:201] offset:0
  s_waitcnt lgkmcnt(5)
  v_mfma_f32_16x16x32_bf16 v[192:195], v[156:159], v[106:109], 0
  v_mfma_f32_16x16x32_bf16 v[192:195], v[160:163], v[110:113], v[192:195]
  v_mfma_f32_16x16x32_bf16 v[192:195], v[164:167], v[114:117], v[192:195]
  v_mfma_f32_16x16x32_bf16 v[192:195], v[168:171], v[118:121], v[192:195]
  v_mfma_f32_16x16x32_bf16 v[208:211], v[172:175], v[106:109], 0
  v_mfma_f32_16x16x32_bf16 v[208:211], v[176:179], v[110:113], v[208:211]
  v_mfma_f32_16x16x32_bf16 v[208:211], v[180:183], v[114:117], v[208:211]
  v_mfma_f32_16x16x32_bf16 v[208:211], v[184:187], v[118:121], v[208:211]
  s_nop 7
  v_pk_mul_f32 v[192:193], v[192:193], s[76:77]
  v_pk_mul_f32 v[194:195], v[194:195], s[76:77]
  v_cvt_pk_bf16_f32 v202, v192, v193
  v_cvt_pk_bf16_f32 v203, v194, v195
  ds_write_b64 v26, v[202:203] offset:5120
  s_waitcnt lgkmcnt(1)
  v_mfma_f32_16x16x32_bf16 v[196:199], v[156:159], v[90:93], 0
  v_mfma_f32_16x16x32_bf16 v[196:199], v[160:163], v[94:97], v[196:199]
  v_mfma_f32_16x16x32_bf16 v[196:199], v[164:167], v[98:101], v[196:199]
  v_mfma_f32_16x16x32_bf16 v[196:199], v[168:171], v[102:105], v[196:199]
  v_mfma_f32_16x16x32_bf16 v[212:215], v[172:175], v[90:93], 0
  v_mfma_f32_16x16x32_bf16 v[212:215], v[176:179], v[94:97], v[212:215]
  v_mfma_f32_16x16x32_bf16 v[212:215], v[180:183], v[98:101], v[212:215]
  v_mfma_f32_16x16x32_bf16 v[212:215], v[184:187], v[102:105], v[212:215]
  s_nop 7
  v_pk_mul_f32 v[196:197], v[196:197], s[76:77]
  v_pk_mul_f32 v[198:199], v[198:199], s[76:77]
  v_cvt_pk_bf16_f32 v200, v196, v197
  v_cvt_pk_bf16_f32 v201, v198, v199
  s_mov_b32 exec_lo, 0x00ff00ff
  s_mov_b32 exec_hi, 0x00ff00ff
  ds_write_b64 v26, v[200:201] offset:10240
  s_mov_b64 exec, -1
  buffer_load_dwordx4 v[216:219], v31, s[32:35], s72 offen offset:0 sc1
  buffer_load_dwordx4 v[220:223], v31, s[32:35], s72 offen offset:1024 sc1
  buffer_load_dwordx4 v[224:227], v31, s[32:35], s72 offen offset:2048 sc1
  buffer_load_dwordx4 v[228:231], v31, s[32:35], s72 offen offset:3072 sc1
  s_or_b32 s100, s2, s3
  s_cmp_lg_u32 s100, 0
  s_cbranch_scc1 K_NONONCE
  s_mov_b64 exec, 1
  v_mov_b32 v2, 65536
  v_mov_b32 v3, s70
  buffer_store_dword v3, v2, s[44:47], 0 offen
  s_mov_b64 exec, -1
  s_waitcnt vmcnt(0)
K_NONONCE:
  s_waitcnt lgkmcnt(0)
  s_barrier
K_NOGEMM:
  ds_read_b32 v34, v14
  ds_read_b32 v33, v13
  ds_read_b128 v[44:47], v15
  s_waitcnt vmcnt(4)
  ds_read_b64_tr_b16 v[90:91], v19 offset:0
  ds_read_b64_tr_b16 v[92:93], v19 offset:1040
  ds_read_b64_tr_b16 v[94:95], v19 offset:2080
  ds_read_b64_tr_b16 v[96:97], v19 offset:3120
  ds_read_b128 v[86:89], v18
  ds_read_b64_tr_b16 v[98:99], v20 offset:0
  ds_read_b64_tr_b16 v[100:101], v20 offset:1040
  ds_read_b64_tr_b16 v[102:103], v20 offset:2080
  ds_read_b64_tr_b16 v[104:105], v20 offset:3120
  ds_read_b64_tr_b16 v[106:107], v21 offset:0
  ds_read_b64_tr_b16 v[108:109], v21 offset:1040
  ds_read_b64_tr_b16 v[110:111], v21 offset:2080
  ds_read_b64_tr_b16 v[112:113], v21 offset:3120
  ds_read_b64_tr_b16 v[114:115], v22 offset:0
  ds_read_b64_tr_b16 v[116:117], v22 offset:1040
  ds_read_b64_tr_b16 v[118:119], v22 offset:2080
  ds_read_b64_tr_b16 v[120:121], v22 offset:3120
  s_waitcnt lgkmcnt(15)
  v_mad_u32_u24 v32, v34, s69, v23
  v_lshrrev_b64 v[42:43], v33, v[40:41]
  ds_read_b64_tr_b16 v[78:79], v32 offset:0
  ds_read_b64_tr_b16 v[80:81], v32 offset:64
  ds_read_b64_tr_b16 v[82:83], v32 offset:128
  ds_read_b64_tr_b16 v[84:85], v32 offset:192
  s_waitcnt lgkmcnt(0)
  s_add_u32 m0, s62, 0
  v_add_u32_dpp v52, v36, v10 row_newbcast:0 row_mask:0xf bank_mask:0xf
  buffer_load_dwordx4 v52, s[20:23], 0 offen sc1 lds
  s_add_u32 m0, s62, 1040
  v_add_u32_dpp v53, v36, v10 row_newbcast:2 row_mask:0xf bank_mask:0xf
  buffer_load_dwordx4 v53, s[20:23], 0 offen sc1 lds
  s_add_u32 m0, s62, 2080
  v_add_u32_dpp v52, v36, v10 row_newbcast:4 row_mask:0xf bank_mask:0xf
  buffer_load_dwordx4 v52, s[20:23], 0 offen sc1 lds
  s_add_u32 m0, s62, 3120
  v_add_u32_dpp v53, v36, v10 row_newbcast:6 row_mask:0xf bank_mask:0xf
  buffer_load_dwordx4 v53, s[20:23], 0 offen sc1 lds
  s_add_u32 m0, s62, 4160
  v_add_u32_dpp v52, v36, v10 row_newbcast:8 row_mask:0xf bank_mask:0xf
  buffer_load_dwordx4 v52, s[20:23], 0 offen sc1 lds
  s_add_u32 m0, s62, 5200
  v_add_u32_dpp v53, v36, v10 row_newbcast:10 row_mask:0xf bank_mask:0xf
  buffer_load_dwordx4 v53, s[20:23], 0 offen sc1 lds
  s_add_u32 m0, s62, 6240
  v_add_u32_dpp v52, v36, v10 row_newbcast:12 row_mask:0xf bank_mask:0xf
  buffer_load_dwordx4 v52, s[20:23], 0 offen sc1 lds
  s_add_u32 m0, s62, 7280
  v_add_u32_dpp v53, v36, v10 row_newbcast:14 row_mask:0xf bank_mask:0xf
  buffer_load_dwordx4 v53, s[20:23], 0 offen sc1 lds
  s_add_u32 m0, s62, 8320
  v_add_u32 v52, v37, v11
  buffer_load_dwordx4 v52, s[24:27], 0 offen  lds
  v_mfma_f32_32x32x16_bf16 v[122:137], v[86:89], v[62:65], 0
  v_smfmac_f32_32x32x32_bf16 v[122:137], v[54:57], v[90:97], v58
  v_mfma_f32_32x32x8bf16_1k v[122:137], v[42:43], v[78:79], v[122:137]
  s_nop 7
  s_nop 3
  s_cmp_eq_u32 s63, 0
  s_cbranch_scc1 K_LOOPEND
  s_cmp_lg_u32 s65, 0
  s_cbranch_scc1 K_SAFE
  s_sub_u32 s63, s63, s59
  s_cmp_eq_u32 s59, 0
  s_cbranch_scc1 K_QUAD
.p2align 6
K_FAST:
  v_mfma_f32_32x32x16_bf16 v[138:153], v[86:89], v[66:69], 0
  v_exp_f32 v156, v122
  v_exp_f32 v157, v123
  v_exp_f32 v158, v124
  v_exp_f32 v159, v125
  v_exp_f32_e64 v160, v126
  v_smfmac_f32_32x32x32_bf16 v[138:153], v[54:57], v[98:105], v58
  v_exp_f32 v161, v127
  v_exp_f32 v162, v128
  v_exp_f32 v163, v129
  v_exp_f32 v172, v130
  v_exp_f32_e64 v173, v131
  v_mfma_f32_32x32x8bf16_1k v[138:153], v[42:43], v[80:81], v[138:153]
  v_exp_f32 v174, v132
  v_exp_f32 v175, v133
  v_exp_f32 v176, v134
  v_exp_f32 v177, v135
  v_exp_f32 v178, v136
  v_exp_f32 v179, v137
  v_pk_add_f32 v[164:165], v[156:157], 1.0 op_sel_hi:[1,0]
  v_pk_fma_f32 v[170:171], v[122:123], v[158:159], v[122:123]
  v_pk_fma_f32 v[166:167], v[164:165], v[158:159], v[164:165]
  v_pk_fma_f32 v[168:169], v[124:125], v[164:165], v[170:171]
  v_mad_u32_u24 v48, v44, s68, v24
  v_mad_u32_u24 v50, v46, s68, v24
  v_pk_fma_f32 v[170:171], v[168:169], v[160:161], v[168:169]
  v_pk_fma_f32 v[164:165], v[166:167], v[160:161], v[166:167]
  v_pk_fma_f32 v[168:169], v[126:127], v[166:167], v[170:171]
  v_pk_fma_f32 v[170:171], v[168:169], v[162:163], v[168:169]
  v_pk_fma_f32 v[166:167], v[164:165], v[162:163], v[164:165]
  v_pk_fma_f32 v[168:169], v[128:129], v[164:165], v[170:171]
  v_pk_fma_f32 v[170:171], v[168:169], v[172:173], v[168:169]
  v_pk_fma_f32 v[164:165], v[166:167], v[172:173], v[166:167]
  v_pk_fma_f32 v[168:169], v[130:131], v[166:167], v[170:171]
  v_pk_fma_f32 v[170:171], v[168:169], v[174:175], v[168:169]
  v_pk_fma_f32 v[166:167], v[164:165], v[174:175], v[164:165]
  v_pk_fma_f32 v[168:169], v[132:133], v[164:165], v[170:171]
  v_pk_fma_f32 v[170:171], v[168:169], v[176:177], v[168:169]
  v_pk_fma_f32 v[164:165], v[166:167], v[176:177], v[166:167]
  v_pk_fma_f32 v[168:169], v[134:135], v[166:167], v[170:171]
  v_pk_fma_f32 v[170:171], v[168:169], v[178:179], v[168:169]
  v_pk_fma_f32 v[236:237], v[164:165], v[178:179], v[164:165]
  v_rcp_f32 v188, v236
  v_rcp_f32 v189, v237
  v_pk_fma_f32 v[168:169], v[136:137], v[164:165], v[170:171]
  s_nop 0
  s_nop 0
  v_pk_mul_f32 v[192:193], v[168:169], v[188:189]
  v_cvt_f64_f32 v[196:197], v192
  v_cvt_f64_f32 v[198:199], v193
  ds_add_f64 v48, v[196:197] offset:0
  ds_add_f64 v50, v[198:199] offset:0
  v_mfma_f32_32x32x16_bf16 v[122:137], v[86:89], v[70:73], 0
  v_exp_f32 v156, v138
  v_exp_f32 v157, v139
  v_exp_f32 v158, v140
  v_exp_f32 v159, v141
  v_exp_f32_e64 v160, v142
  v_smfmac_f32_32x32x32_bf16 v[122:137], v[54:57], v[106:113], v58
  v_exp_f32 v161, v143
  v_exp_f32 v162, v144
  v_exp_f32 v163, v145
  v_exp_f32 v172, v146
  v_exp_f32_e64 v173, v147
  v_mfma_f32_32x32x8bf16_1k v[122:137], v[42:43], v[82:83], v[122:137]
  v_exp_f32 v174, v148
  v_exp_f32 v175, v149
  v_exp_f32 v176, v150
  v_exp_f32 v177, v151
  v_exp_f32 v178, v152
  v_exp_f32 v179, v153
  v_pk_add_f32 v[164:165], v[156:157], 1.0 op_sel_hi:[1,0]
  v_pk_fma_f32 v[170:171], v[138:139], v[158:159], v[138:139]
  v_pk_fma_f32 v[166:167], v[164:165], v[158:159], v[164:165]
  v_pk_fma_f32 v[168:169], v[140:141], v[164:165], v[170:171]
  v_pk_fma_f32 v[170:171], v[168:169], v[160:161], v[168:169]
  v_pk_fma_f32 v[164:165], v[166:167], v[160:161], v[166:167]
  v_pk_fma_f32 v[168:169], v[142:143], v[166:167], v[170:171]
  v_pk_fma_f32 v[170:171], v[168:169], v[162:163], v[168:169]
  ds_read_b64 v[36:37], v12 offset:4096
  ds_read_b32 v34, v14 offset:256
  ds_read_b32 v33, v13 offset:2048
  ds_read_b128 v[44:47], v15 offset:256
  v_pk_fma_f32 v[166:167], v[164:165], v[162:163], v[164:165]
  v_pk_fma_f32 v[168:169], v[144:145], v[164:165], v[170:171]
  v_pk_fma_f32 v[170:171], v[168:169], v[172:173], v[168:169]
  v_pk_fma_f32 v[164:165], v[166:167], v[172:173], v[166:167]
  v_pk_fma_f32 v[168:169], v[146:147], v[166:167], v[170:171]
  v_pk_fma_f32 v[170:171], v[168:169], v[174:175], v[168:169]
  v_pk_fma_f32 v[166:167], v[164:165], v[174:175], v[164:165]
  v_pk_fma_f32 v[168:169], v[148:149], v[164:165], v[170:171]
  v_pk_fma_f32 v[170:171], v[168:169], v[176:177], v[168:169]
  v_pk_fma_f32 v[164:165], v[166:167], v[176:177], v[166:167]
  v_pk_fma_f32 v[168:169], v[150:151], v[166:167], v[170:171]
  v_pk_fma_f32 v[170:171], v[168:169], v[178:179], v[168:169]
  v_pk_fma_f32 v[238:239], v[164:165], v[178:179], v[164:165]
  v_rcp_f32 v188, v238
  v_rcp_f32 v189, v239
  v_pk_fma_f32 v[168:169], v[152:153], v[164:165], v[170:171]
  v_pk_fma_f32 v[38:39], v[236:237], v[238:239], v[38:39]
  v_pk_mul_f32 v[192:193], v[168:169], v[188:189]
  v_cvt_f64_f32 v[196:197], v192
  v_cvt_f64_f32 v[198:199], v193
  ds_add_f64 v48, v[196:197] offset:256
  ds_add_f64 v50, v[198:199] offset:256
  v_mfma_f32_32x32x16_bf16 v[138:153], v[86:89], v[74:77], 0
  v_exp_f32 v156, v122
  v_exp_f32 v157, v123
  v_exp_f32 v158, v124
  v_exp_f32 v159, v125
  v_exp_f32_e64 v160, v126
  v_smfmac_f32_32x32x32_bf16 v[138:153], v[54:57], v[114:121], v58
  v_exp_f32 v161, v127
  v_exp_f32 v162, v128
  v_exp_f32 v163, v129
  v_exp_f32 v172, v130
  v_exp_f32_e64 v173, v131
  v_mfma_f32_32x32x8bf16_1k v[138:153], v[42:43], v[84:85], v[138:153]
  v_exp_f32 v174, v132
  v_exp_f32 v175, v133
  v_exp_f32 v176, v134
  v_exp_f32 v177, v135
  v_exp_f32 v178, v136
  v_exp_f32 v179, v137
  v_pk_add_f32 v[164:165], v[156:157], 1.0 op_sel_hi:[1,0]
  v_pk_fma_f32 v[170:171], v[122:123], v[158:159], v[122:123]
  v_pk_fma_f32 v[166:167], v[164:165], v[158:159], v[164:165]
  v_pk_fma_f32 v[168:169], v[124:125], v[164:165], v[170:171]
  v_pk_fma_f32 v[170:171], v[168:169], v[160:161], v[168:169]
  v_pk_fma_f32 v[164:165], v[166:167], v[160:161], v[166:167]
  v_pk_fma_f32 v[168:169], v[126:127], v[166:167], v[170:171]
  v_pk_fma_f32 v[170:171], v[168:169], v[162:163], v[168:169]
  v_pk_fma_f32 v[166:167], v[164:165], v[162:163], v[164:165]
  v_pk_fma_f32 v[168:169], v[128:129], v[164:165], v[170:171]
  s_waitcnt vmcnt(0) lgkmcnt(2)
  s_nop 0
  v_mad_u32_u24 v32, v34, s69, v23
  ds_read_b64_tr_b16 v[90:91], v19 offset:0
  ds_read_b64_tr_b16 v[92:93], v19 offset:1040
  ds_read_b64_tr_b16 v[94:95], v19 offset:2080
  ds_read_b64_tr_b16 v[96:97], v19 offset:3120
  ds_read_b128 v[86:89], v18
  ds_read_b64_tr_b16 v[98:99], v20 offset:0
  ds_read_b64_tr_b16 v[100:101], v20 offset:1040
  ds_read_b64_tr_b16 v[102:103], v20 offset:2080
  ds_read_b64_tr_b16 v[104:105], v20 offset:3120
  ds_read_b64_tr_b16 v[106:107], v21 offset:0
  ds_read_b64_tr_b16 v[108:109], v21 offset:1040
  ds_read_b64_tr_b16 v[110:111], v21 offset:2080
  ds_read_b64_tr_b16 v[112:113], v21 offset:3120
  ds_read_b64_tr_b16 v[114:115], v22 offset:0
  ds_read_b64_tr_b16 v[116:117], v22 offset:1040
  ds_read_b64_tr_b16 v[118:119], v22 offset:2080
  ds_read_b64_tr_b16 v[120:121], v22 offset:3120
  ds_read_b64_tr_b16 v[78:79], v32 offset:0
  ds_read_b64_tr_b16 v[80:81], v32 offset:64
  ds_read_b64_tr_b16 v[82:83], v32 offset:128
  ds_read_b64_tr_b16 v[84:85], v32 offset:192
  v_lshrrev_b64 v[42:43], v33, v[40:41]
  v_pk_fma_f32 v[170:171], v[168:169], v[172:173], v[168:169]
  v_pk_fma_f32 v[164:165], v[166:167], v[172:173], v[166:167]
  v_pk_fma_f32 v[168:169], v[130:131], v[166:167], v[170:171]
  v_pk_fma_f32 v[170:171], v[168:169], v[174:175], v[168:169]
  v_pk_fma_f32 v[166:167], v[164:165], v[174:175], v[164:165]
  v_pk_fma_f32 v[168:169], v[132:133], v[164:165], v[170:171]
  v_pk_fma_f32 v[170:171], v[168:169], v[176:177], v[168:169]
  v_pk_fma_f32 v[164:165], v[166:167], v[176:177], v[166:167]
  v_pk_fma_f32 v[168:169], v[134:135], v[166:167], v[170:171]
  v_pk_fma_f32 v[170:171], v[168:169], v[178:179], v[168:169]
  v_pk_fma_f32 v[236:237], v[164:165], v[178:179], v[164:165]
  v_rcp_f32 v188, v236
  v_rcp_f32 v189, v237
  v_pk_fma_f32 v[168:169], v[136:137], v[164:165], v[170:171]
  s_nop 0
  s_nop 0
  v_pk_mul_f32 v[192:193], v[168:169], v[188:189]
  v_cvt_f64_f32 v[196:197], v192
  v_cvt_f64_f32 v[198:199], v193
  ds_add_f64 v48, v[196:197] offset:512
  ds_add_f64 v50, v[198:199] offset:512
  s_waitcnt lgkmcnt(2)
  s_nop 0
  v_mfma_f32_32x32x16_bf16 v[122:137], v[86:89], v[62:65], 0
  v_exp_f32 v156, v138
  v_exp_f32 v157, v139
  v_exp_f32 v158, v140
  v_exp_f32 v159, v141
  v_exp_f32 v160, v142
  s_add_u32 m0, s62, 0
  v_add_u32_dpp v52, v36, v10 row_newbcast:0 row_mask:0xf bank_mask:0xf
  buffer_load_dwordx4 v52, s[20:23], 0 offen sc1 lds
  s_add_u32 m0, s62, 1040
  v_add_u32_dpp v53, v36, v10 row_newbcast:2 row_mask:0xf bank_mask:0xf
  buffer_load_dwordx4 v53, s[20:23], 0 offen sc1 lds
  v_smfmac_f32_32x32x32_bf16 v[122:137], v[54:57], v[90:97], v58
  v_exp_f32 v161, v143
  v_exp_f32 v162, v144
  v_exp_f32 v163, v145
  v_exp_f32 v172, v146
  v_exp_f32_e64 v173, v147
  s_add_u32 m0, s62, 2080
  v_add_u32_dpp v52, v36, v10 row_newbcast:4 row_mask:0xf bank_mask:0xf
  buffer_load_dwordx4 v52, s[20:23], 0 offen sc1 lds
  s_add_u32 m0, s62, 3120
  v_add_u32_dpp v53, v36, v10 row_newbcast:6 row_mask:0xf bank_mask:0xf
  buffer_load_dwordx4 v53, s[20:23], 0 offen sc1 lds
  v_mfma_f32_32x32x8bf16_1k v[122:137], v[42:43], v[78:79], v[122:137]
  v_exp_f32 v174, v148
  v_exp_f32 v175, v149
  v_exp_f32 v176, v150
  v_exp_f32 v177, v151
  v_exp_f32 v178, v152
  v_exp_f32 v179, v153
  s_add_u32 m0, s62, 4160
  v_add_u32_dpp v52, v36, v10 row_newbcast:8 row_mask:0xf bank_mask:0xf
  buffer_load_dwordx4 v52, s[20:23], 0 offen sc1 lds
  s_add_u32 m0, s62, 5200
  v_add_u32_dpp v53, v36, v10 row_newbcast:10 row_mask:0xf bank_mask:0xf
  buffer_load_dwordx4 v53, s[20:23], 0 offen sc1 lds
  s_add_u32 m0, s62, 6240
  v_add_u32_dpp v52, v36, v10 row_newbcast:12 row_mask:0xf bank_mask:0xf
  buffer_load_dwordx4 v52, s[20:23], 0 offen sc1 lds
  s_add_u32 m0, s62, 7280
  v_add_u32_dpp v53, v36, v10 row_newbcast:14 row_mask:0xf bank_mask:0xf
  buffer_load_dwordx4 v53, s[20:23], 0 offen sc1 lds
  s_add_u32 m0, s62, 8320
  v_add_u32_e64 v52, v37, v11
  buffer_load_dwordx4 v52, s[24:27], 0 offen  lds
  v_pk_add_f32 v[164:165], v[156:157], 1.0 op_sel_hi:[1,0]
  v_pk_fma_f32 v[170:171], v[138:139], v[158:159], v[138:139]
  v_pk_fma_f32 v[166:167], v[164:165], v[158:159], v[164:165]
  v_pk_fma_f32 v[168:169], v[140:141], v[164:165], v[170:171]
  v_pk_fma_f32 v[170:171], v[168:169], v[160:161], v[168:169]
  v_pk_fma_f32 v[164:165], v[166:167], v[160:161], v[166:167]
  v_pk_fma_f32 v[168:169], v[142:143], v[166:167], v[170:171]
  v_pk_fma_f32 v[170:171], v[168:169], v[162:163], v[168:169]
  v_pk_fma_f32 v[166:167], v[164:165], v[162:163], v[164:165]
  v_pk_fma_f32 v[168:169], v[144:145], v[164:165], v[170:171]
  v_pk_fma_f32 v[170:171], v[168:169], v[172:173], v[168:169]
  v_pk_fma_f32 v[164:165], v[166:167], v[172:173], v[166:167]
  v_pk_fma_f32 v[168:169], v[146:147], v[166:167], v[170:171]
  v_pk_fma_f32 v[170:171], v[168:169], v[174:175], v[168:169]
  v_pk_fma_f32 v[166:167], v[164:165], v[174:175], v[164:165]
  v_pk_fma_f32 v[168:169], v[148:149], v[164:165], v[170:171]
  v_pk_fma_f32 v[170:171], v[168:169], v[176:177], v[168:169]
  v_pk_fma_f32 v[164:165], v[166:167], v[176:177], v[166:167]
  v_pk_fma_f32 v[168:169], v[150:151], v[166:167], v[170:171]
  v_pk_fma_f32 v[170:171], v[168:169], v[178:179], v[168:169]
  v_pk_fma_f32 v[238:239], v[164:165], v[178:179], v[164:165]
  v_rcp_f32 v188, v238
  v_rcp_f32 v189, v239
  v_pk_fma_f32 v[168:169], v[152:153], v[164:165], v[170:171]
  v_pk_fma_f32 v[38:39], v[236:237], v[238:239], v[38:39]
  v_pk_mul_f32 v[192:193], v[168:169], v[188:189]
  v_cvt_f64_f32 v[196:197], v192
  v_cvt_f64_f32 v[198:199], v193
  ds_add_f64 v48, v[196:197] offset:768
  ds_add_f64 v50, v[198:199] offset:768
  s_sub_u32 s59, s59, 1
  s_cmp_lg_u32 s59, 0
  s_cbranch_scc0 K_OX0
  s_nop 0
  v_mfma_f32_32x32x16_bf16 v[138:153], v[86:89], v[66:69], 0
  v_exp_f32 v156, v122
  v_exp_f32 v157, v123
  v_exp_f32 v158, v124
  v_exp_f32 v159, v125
  v_exp_f32_e64 v160, v126
  v_smfmac_f32_32x32x32_bf16 v[138:153], v[54:57], v[98:105], v58
  v_exp_f32 v161, v127
  v_exp_f32 v162, v128
  v_exp_f32 v163, v129
  v_exp_f32 v172, v130
  v_exp_f32_e64 v173, v131
  v_mfma_f32_32x32x8bf16_1k v[138:153], v[42:43], v[80:81], v[138:153]
  v_exp_f32 v174, v132
  v_exp_f32 v175, v133
  v_exp_f32 v176, v134
  v_exp_f32 v177, v135
  v_exp_f32 v178, v136
  v_exp_f32 v179, v137
  v_pk_add_f32 v[164:165], v[156:157], 1.0 op_sel_hi:[1,0]
  v_pk_fma_f32 v[170:171], v[122:123], v[158:159], v[122:123]
  v_pk_fma_f32 v[166:167], v[164:165], v[158:159], v[164:165]
  v_pk_fma_f32 v[168:169], v[124:125], v[164:165], v[170:171]
  v_mad_u32_u24 v48, v44, s68, v24
  v_mad_u32_u24 v50, v46, s68, v24
  v_pk_fma_f32 v[170:171], v[168:169], v[160:161], v[168:169]
  v_pk_fma_f32 v[164:165], v[166:167], v[160:161], v[166:167]
  v_pk_fma_f32 v[168:169], v[126:127], v[166:167], v[170:171]
  v_pk_fma_f32 v[170:171], v[168:169], v[162:163], v[168:169]
  v_pk_fma_f32 v[166:167], v[164:165], v[162:163], v[164:165]
  v_pk_fma_f32 v[168:169], v[128:129], v[164:165], v[170:171]
  v_pk_fma_f32 v[170:171], v[168:169], v[172:173], v[168:169]
  v_pk_fma_f32 v[164:165], v[166:167], v[172:173], v[166:167]
  v_pk_fma_f32 v[168:169], v[130:131], v[166:167], v[170:171]
  v_pk_fma_f32 v[170:171], v[168:169], v[174:175], v[168:169]
  v_pk_fma_f32 v[166:167], v[164:165], v[174:175], v[164:165]
  v_pk_fma_f32 v[168:169], v[132:133], v[164:165], v[170:171]
  v_pk_fma_f32 v[170:171], v[168:169], v[176:177], v[168:169]
  v_pk_fma_f32 v[164:165], v[166:167], v[176:177], v[166:167]
  v_pk_fma_f32 v[168:169], v[134:135], v[166:167], v[170:171]
  v_pk_fma_f32 v[170:171], v[168:169], v[178:179], v[168:169]
  v_pk_fma_f32 v[236:237], v[164:165], v[178:179], v[164:165]
  v_rcp_f32 v188, v236
  v_rcp_f32 v189, v237
  v_pk_fma_f32 v[168:169], v[136:137], v[164:165], v[170:171]
  s_nop 0
  s_nop 0
  v_pk_mul_f32 v[192:193], v[168:169], v[188:189]
  v_cvt_f64_f32 v[196:197], v192
  v_cvt_f64_f32 v[198:199], v193
  ds_add_f64 v48, v[196:197] offset:0
  ds_add_f64 v50, v[198:199] offset:0
  v_mfma_f32_32x32x16_bf16 v[122:137], v[86:89], v[70:73], 0
  v_exp_f32 v156, v138
  v_exp_f32 v157, v139
  v_exp_f32 v158, v140
  v_exp_f32 v159, v141
  v_exp_f32_e64 v160, v142
  v_smfmac_f32_32x32x32_bf16 v[122:137], v[54:57], v[106:113], v58
  v_exp_f32 v161, v143
  v_exp_f32 v162, v144
  v_exp_f32 v163, v145
  v_exp_f32 v172, v146
  v_exp_f32_e64 v173, v147
  v_mfma_f32_32x32x8bf16_1k v[122:137], v[42:43], v[82:83], v[122:137]
  v_exp_f32 v174, v148
  v_exp_f32 v175, v149
  v_exp_f32 v176, v150
  v_exp_f32 v177, v151
  v_exp_f32 v178, v152
  v_exp_f32 v179, v153
  v_pk_add_f32 v[164:165], v[156:157], 1.0 op_sel_hi:[1,0]
  v_pk_fma_f32 v[170:171], v[138:139], v[158:159], v[138:139]
  v_pk_fma_f32 v[166:167], v[164:165], v[158:159], v[164:165]
  v_pk_fma_f32 v[168:169], v[140:141], v[164:165], v[170:171]
  v_pk_fma_f32 v[170:171], v[168:169], v[160:161], v[168:169]
  v_pk_fma_f32 v[164:165], v[166:167], v[160:161], v[166:167]
  v_pk_fma_f32 v[168:169], v[142:143], v[166:167], v[170:171]
  v_pk_fma_f32 v[170:171], v[168:169], v[162:163], v[168:169]
  ds_read_b64 v[36:37], v12 offset:6144
  ds_read_b32 v34, v14 offset:512
  ds_read_b32 v33, v13 offset:4096
  ds_read_b128 v[44:47], v15 offset:512
  v_pk_fma_f32 v[166:167], v[164:165], v[162:163], v[164:165]
  v_pk_fma_f32 v[168:169], v[144:145], v[164:165], v[170:171]
  v_pk_fma_f32 v[170:171], v[168:169], v[172:173], v[168:169]
  v_pk_fma_f32 v[164:165], v[166:167], v[172:173], v[166:167]
  v_pk_fma_f32 v[168:169], v[146:147], v[166:167], v[170:171]
  v_pk_fma_f32 v[170:171], v[168:169], v[174:175], v[168:169]
  v_pk_fma_f32 v[166:167], v[164:165], v[174:175], v[164:165]
  v_pk_fma_f32 v[168:169], v[148:149], v[164:165], v[170:171]
  v_pk_fma_f32 v[170:171], v[168:169], v[176:177], v[168:169]
  v_pk_fma_f32 v[164:165], v[166:167], v[176:177], v[166:167]
  v_pk_fma_f32 v[168:169], v[150:151], v[166:167], v[170:171]
  v_pk_fma_f32 v[170:171], v[168:169], v[178:179], v[168:169]
  v_pk_fma_f32 v[238:239], v[164:165], v[178:179], v[164:165]
  v_rcp_f32 v188, v238
  v_rcp_f32 v189, v239
  v_pk_fma_f32 v[168:169], v[152:153], v[164:165], v[170:171]
  v_pk_fma_f32 v[38:39], v[236:237], v[238:239], v[38:39]
  v_pk_mul_f32 v[192:193], v[168:169], v[188:189]
  v_cvt_f64_f32 v[196:197], v192
  v_cvt_f64_f32 v[198:199], v193
  ds_add_f64 v48, v[196:197] offset:256
  ds_add_f64 v50, v[198:199] offset:256
  v_mfma_f32_32x32x16_bf16 v[138:153], v[86:89], v[74:77], 0
  v_exp_f32 v156, v122
  v_exp_f32 v157, v123
  v_exp_f32 v158, v124
  v_exp_f32 v159, v125
  v_exp_f32_e64 v160, v126
  v_smfmac_f32_32x32x32_bf16 v[138:153], v[54:57], v[114:121], v58
  v_exp_f32 v161, v127
  v_exp_f32 v162, v128
  v_exp_f32 v163, v129
  v_exp_f32 v172, v130
  v_exp_f32_e64 v173, v131
  v_mfma_f32_32x32x8bf16_1k v[138:153], v[42:43], v[84:85], v[138:153]
  v_exp_f32 v174, v132
  v_exp_f32 v175, v133
  v_exp_f32 v176, v134
  v_exp_f32 v177, v135
  v_exp_f32 v178, v136
  v_exp_f32 v179, v137
  v_pk_add_f32 v[164:165], v[156:157], 1.0 op_sel_hi:[1,0]
  v_pk_fma_f32 v[170:171], v[122:123], v[158:159], v[122:123]
  v_pk_fma_f32 v[166:167], v[164:165], v[158:159], v[164:165]
  v_pk_fma_f32 v[168:169], v[124:125], v[164:165], v[170:171]
  v_pk_fma_f32 v[170:171], v[168:169], v[160:161], v[168:169]
  v_pk_fma_f32 v[164:165], v[166:167], v[160:161], v[166:167]
  v_pk_fma_f32 v[168:169], v[126:127], v[166:167], v[170:171]
  v_pk_fma_f32 v[170:171], v[168:169], v[162:163], v[168:169]
  v_pk_fma_f32 v[166:167], v[164:165], v[162:163], v[164:165]
  v_pk_fma_f32 v[168:169], v[128:129], v[164:165], v[170:171]
  s_waitcnt vmcnt(0) lgkmcnt(2)
  s_nop 0
  v_mad_u32_u24 v32, v34, s69, v23
  ds_read_b64_tr_b16 v[90:91], v19 offset:0
  ds_read_b64_tr_b16 v[92:93], v19 offset:1040
  ds_read_b64_tr_b16 v[94:95], v19 offset:2080
  ds_read_b64_tr_b16 v[96:97], v19 offset:3120
  ds_read_b128 v[86:89], v18
  ds_read_b64_tr_b16 v[98:99], v20 offset:0
  ds_read_b64_tr_b16 v[100:101], v20 offset:1040
  ds_read_b64_tr_b16 v[102:103], v20 offset:2080
  ds_read_b64_tr_b16 v[104:105], v20 offset:3120
  ds_read_b64_tr_b16 v[106:107], v21 offset:0
  ds_read_b64_tr_b16 v[108:109], v21 offset:1040
  ds_read_b64_tr_b16 v[110:111], v21 offset:2080
  ds_read_b64_tr_b16 v[112:113], v21 offset:3120
  ds_read_b64_tr_b16 v[114:115], v22 offset:0
  ds_read_b64_tr_b16 v[116:117], v22 offset:1040
  ds_read_b64_tr_b16 v[118:119], v22 offset:2080
  ds_read_b64_tr_b16 v[120:121], v22 offset:3120
  ds_read_b64_tr_b16 v[78:79], v32 offset:0
  ds_read_b64_tr_b16 v[80:81], v32 offset:64
  ds_read_b64_tr_b16 v[82:83], v32 offset:128
  ds_read_b64_tr_b16 v[84:85], v32 offset:192
  v_lshrrev_b64 v[42:43], v33, v[40:41]
  v_pk_fma_f32 v[170:171], v[168:169], v[172:173], v[168:169]
  v_pk_fma_f32 v[164:165], v[166:167], v[172:173], v[166:167]
  v_pk_fma_f32 v[168:169], v[130:131], v[166:167], v[170:171]
  v_pk_fma_f32 v[170:171], v[168:169], v[174:175], v[168:169]
  v_pk_fma_f32 v[166:167], v[164:165], v[174:175], v[164:165]
  v_pk_fma_f32 v[168:169], v[132:133], v[164:165], v[170:171]
  v_pk_fma_f32 v[170:171], v[168:169], v[176:177], v[168:169]
  v_pk_fma_f32 v[164:165], v[166:167], v[176:177], v[166:167]
  v_pk_fma_f32 v[168:169], v[134:135], v[166:167], v[170:171]
  v_pk_fma_f32 v[170:171], v[168:169], v[178:179], v[168:169]
  v_pk_fma_f32 v[236:237], v[164:165], v[178:179], v[164:165]
  v_rcp_f32 v188, v236
  v_rcp_f32 v189, v237
  v_pk_fma_f32 v[168:169], v[136:137], v[164:165], v[170:171]
  s_nop 0
  s_nop 0
  v_pk_mul_f32 v[192:193], v[168:169], v[188:189]
  v_cvt_f64_f32 v[196:197], v192
  v_cvt_f64_f32 v[198:199], v193
  ds_add_f64 v48, v[196:197] offset:512
  ds_add_f64 v50, v[198:199] offset:512
  s_waitcnt lgkmcnt(2)
  s_nop 0
  v_mfma_f32_32x32x16_bf16 v[122:137], v[86:89], v[62:65], 0
  v_exp_f32 v156, v138
  v_exp_f32 v157, v139
  v_exp_f32 v158, v140
  v_exp_f32 v159, v141
  v_exp_f32 v160, v142
  s_add_u32 m0, s62, 0
  v_add_u32_dpp v52, v36, v10 row_newbcast:0 row_mask:0xf bank_mask:0xf
  buffer_load_dwordx4 v52, s[20:23], 0 offen sc1 lds
  s_add_u32 m0, s62, 1040
  v_add_u32_dpp v53, v36, v10 row_newbcast:2 row_mask:0xf bank_mask:0xf
  buffer_load_dwordx4 v53, s[20:23], 0 offen sc1 lds
  v_smfmac_f32_32x32x32_bf16 v[122:137], v[54:57], v[90:97], v58
  v_exp_f32 v161, v143
  v_exp_f32 v162, v144
  v_exp_f32 v163, v145
  v_exp_f32 v172, v146
  v_exp_f32_e64 v173, v147
  s_add_u32 m0, s62, 2080
  v_add_u32_dpp v52, v36, v10 row_newbcast:4 row_mask:0xf bank_mask:0xf
  buffer_load_dwordx4 v52, s[20:23], 0 offen sc1 lds
  s_add_u32 m0, s62, 3120
  v_add_u32_dpp v53, v36, v10 row_newbcast:6 row_mask:0xf bank_mask:0xf
  buffer_load_dwordx4 v53, s[20:23], 0 offen sc1 lds
  v_mfma_f32_32x32x8bf16_1k v[122:137], v[42:43], v[78:79], v[122:137]
  v_exp_f32 v174, v148
  v_exp_f32 v175, v149
  v_exp_f32 v176, v150
  v_exp_f32 v177, v151
  v_exp_f32 v178, v152
  v_exp_f32 v179, v153
  s_add_u32 m0, s62, 4160
  v_add_u32_dpp v52, v36, v10 row_newbcast:8 row_mask:0xf bank_mask:0xf
  buffer_load_dwordx4 v52, s[20:23], 0 offen sc1 lds
  s_add_u32 m0, s62, 5200
  v_add_u32_dpp v53, v36, v10 row_newbcast:10 row_mask:0xf bank_mask:0xf
  buffer_load_dwordx4 v53, s[20:23], 0 offen sc1 lds
  s_add_u32 m0, s62, 6240
  v_add_u32_dpp v52, v36, v10 row_newbcast:12 row_mask:0xf bank_mask:0xf
  buffer_load_dwordx4 v52, s[20:23], 0 offen sc1 lds
  s_add_u32 m0, s62, 7280
  v_add_u32_dpp v53, v36, v10 row_newbcast:14 row_mask:0xf bank_mask:0xf
  buffer_load_dwordx4 v53, s[20:23], 0 offen sc1 lds
  s_add_u32 m0, s62, 8320
  v_add_u32_e64 v52, v37, v11
  buffer_load_dwordx4 v52, s[24:27], 0 offen  lds
  v_pk_add_f32 v[164:165], v[156:157], 1.0 op_sel_hi:[1,0]
  v_pk_fma_f32 v[170:171], v[138:139], v[158:159], v[138:139]
  v_pk_fma_f32 v[166:167], v[164:165], v[158:159], v[164:165]
  v_pk_fma_f32 v[168:169], v[140:141], v[164:165], v[170:171]
  v_pk_fma_f32 v[170:171], v[168:169], v[160:161], v[168:169]
  v_pk_fma_f32 v[164:165], v[166:167], v[160:161], v[166:167]
  v_pk_fma_f32 v[168:169], v[142:143], v[166:167], v[170:171]
  v_pk_fma_f32 v[170:171], v[168:169], v[162:163], v[168:169]
  v_pk_fma_f32 v[166:167], v[164:165], v[162:163], v[164:165]
  v_pk_fma_f32 v[168:169], v[144:145], v[164:165], v[170:171]
  v_pk_fma_f32 v[170:171], v[168:169], v[172:173], v[168:169]
  v_pk_fma_f32 v[164:165], v[166:167], v[172:173], v[166:167]
  v_pk_fma_f32 v[168:169], v[146:147], v[166:167], v[170:171]
  v_pk_fma_f32 v[170:171], v[168:169], v[174:175], v[168:169]
  v_pk_fma_f32 v[166:167], v[164:165], v[174:175], v[164:165]
  v_pk_fma_f32 v[168:169], v[148:149], v[164:165], v[170:171]
  v_pk_fma_f32 v[170:171], v[168:169], v[176:177], v[168:169]
  v_pk_fma_f32 v[164:165], v[166:167], v[176:177], v[166:167]
  v_pk_fma_f32 v[168:169], v[150:151], v[166:167], v[170:171]
  v_pk_fma_f32 v[170:171], v[168:169], v[178:179], v[168:169]
  v_pk_fma_f32 v[238:239], v[164:165], v[178:179], v[164:165]
  v_rcp_f32 v188, v238
  v_rcp_f32 v189, v239
  v_pk_fma_f32 v[168:169], v[152:153], v[164:165], v[170:171]
  v_pk_fma_f32 v[38:39], v[236:237], v[238:239], v[38:39]
  v_pk_mul_f32 v[192:193], v[168:169], v[188:189]
  v_add_u32 v12, 4096, v12
  v_add_u32 v13, 4096, v13
  v_add_u32 v14, 512, v14
  v_add_u32 v15, 512, v15
  v_cvt_f64_f32 v[196:197], v192
  v_cvt_f64_f32 v[198:199], v193
  ds_add_f64 v48, v[196:197] offset:768
  ds_add_f64 v50, v[198:199] offset:768
  s_sub_u32 s59, s59, 1
  s_cmp_lg_u32 s59, 0
  s_cbranch_scc1 K_FAST
K_OXE:
  s_cmp_lg_u32 s63, 0
  s_cbranch_scc1 K_QUAD
K_LOOPEND:
  s_waitcnt vmcnt(0) lgkmcnt(0)
  s_barrier
  s_cmp_lg_u32 s66, 0
  s_cbranch_scc1 K_NEXT
K_CELLSDONE:
  v_mov_b32 v2, 21248
  ds_read_b128 v[196:199], v2
K_CONV:
  s_mul_i32 s4, s3, 1040
  s_add_u32 s4, s4, 21280
  v_lshlrev_b32 v3, 4, v1
  v_add_u32 v3, s4, v3
  ds_read_b128 v[122:125], v3 offset:0
  ds_read_b128 v[126:129], v3 offset:8320
  ds_read_b128 v[130:133], v3 offset:16640
  ds_read_b128 v[134:137], v3 offset:24960
  ds_read_b128 v[138:141], v3 offset:33280
  s_mul_i32 s4, s3, 288
  s_add_u32 s4, s4, 75680
  v_lshlrev_b32 v4, 2, v1
  v_add_u32 v4, s4, v4
  s_cmp_ge_u32 s66, 3
  s_cbranch_scc1 K_CONV2
  s_waitcnt lgkmcnt(5)
  v_or3_b32 v2, v196, v197, v198
  v_or_b32 v2, v2, v199
  v_cmp_ne_u32 vcc, 0, v2
  s_cbranch_vccnz K_STARTOV
K_CONV2:
  s_mov_b32 s4, 0x71800000
  v_cmp_nle_f32 s[78:79], v38, s4
  v_cmp_nle_f32 vcc, v39, s4
  s_or_b64 s[78:79], s[78:79], vcc
  s_movk_i32 s4, 0x207
  s_waitcnt lgkmcnt(4)
  v_cvt_f32_f64 v156, v[122:123]
  v_cvt_f32_f64 v157, v[124:125]
  v_cvt_pk_bf16_f32 v172, v156, v157
  ds_write_b32 v4, v172 offset:0
  s_waitcnt lgkmcnt(4)
  v_cvt_f32_f64 v158, v[126:127]
  v_cvt_f32_f64 v159, v[128:129]
  v_cvt_pk_bf16_f32 v173, v158, v159
  ds_write_b32 v4, v173 offset:2304
  s_waitcnt lgkmcnt(4)
  v_cvt_f32_f64 v160, v[130:131]
  v_cvt_f32_f64 v161, v[132:133]
  v_cvt_pk_bf16_f32 v174, v160, v161
  ds_write_b32 v4, v174 offset:4608
  s_waitcnt lgkmcnt(4)
  v_cvt_f32_f64 v162, v[134:135]
  v_cvt_f32_f64 v163, v[136:137]
  v_cvt_pk_bf16_f32 v175, v162, v163
  ds_write_b32 v4, v175 offset:6912
  s_waitcnt lgkmcnt(4)
  v_cvt_f32_f64 v164, v[138:139]
  v_cvt_f32_f64 v165, v[140:141]
  v_cvt_pk_bf16_f32 v176, v164, v165
  ds_write_b32 v4, v176 offset:9216
  v_pk_mul_f32 v[188:189], v[156:157], 0 op_sel_hi:[1,0]
  v_pk_fma_f32 v[188:189], v[158:159], 0, v[188:189] op_sel_hi:[1,0,1]
  v_pk_fma_f32 v[188:189], v[160:161], 0, v[188:189] op_sel_hi:[1,0,1]
  v_pk_fma_f32 v[188:189], v[162:163], 0, v[188:189] op_sel_hi:[1,0,1]
  v_pk_fma_f32 v[188:189], v[164:165], 0, v[188:189] op_sel_hi:[1,0,1]
  v_add_f32 v188, v188, v189
  v_cmp_class_f32 vcc, v188, s4
  s_or_b64 s[78:79], s[78:79], vcc
  s_cmp_eq_u64 s[78:79], 0
  s_cbranch_scc1 K_OKW
  v_mov_b32 v2, 21216
  ds_write_b32 v2, v28
K_OKW:
  s_mov_b32 s76, 3207688728
  s_mov_b32 s77, 3207688728
  s_mov_b32 s4, 3216550459
  s_mov_b32 s5, 3216550459
  v_and_b32 v7, 15, v1
  v_lshlrev_b32 v7, 8, v7
  v_lshrrev_b32 v8, 4, v1
  v_lshl_add_u32 v7, v8, 3, v7
  s_lshl_b32 s6, s3, 5
  v_add_u32 v7, s6, v7
  v_add_u32 v8, 4096, v7
  v_add_u32 v9, 8192, v7
  v_mov_b32 v2, 21216
  s_waitcnt lgkmcnt(0)
  s_barrier
  ds_read_b32 v2, v2
  ds_read_b128 v[90:93], v25 offset:0
  ds_read_b128 v[94:97], v25 offset:64
  ds_read_b128 v[98:101], v25 offset:128
  ds_read_b128 v[102:105], v25 offset:192
  ds_read_b128 v[106:109], v25 offset:4608
  ds_read_b128 v[110:113], v25 offset:4672
  ds_read_b128 v[114:117], v25 offset:4736
  ds_read_b128 v[118:121], v25 offset:4800
  ds_read_b128 v[138:141], v25 offset:9216
  ds_read_b128 v[142:145], v25 offset:9280
  ds_read_b128 v[146:149], v25 offset:9344
  ds_read_b128 v[150:153], v25 offset:9408
  s_waitcnt lgkmcnt(8)
  v_readfirstlane_b32 s6, v2
  v_mfma_f32_16x16x32_bf16 v[122:125], v[216:219], v[90:93], 0
  v_mfma_f32_16x16x32_bf16 v[122:125], v[220:223], v[94:97], v[122:125]
  v_mfma_f32_16x16x32_bf16 v[122:125], v[224:227], v[98:101], v[122:125]
  v_mfma_f32_16x16x32_bf16 v[122:125], v[228:231], v[102:105], v[122:125]
  s_waitcnt lgkmcnt(4)
  v_mfma_f32_16x16x32_bf16 v[126:129], v[216:219], v[106:109], 0
  v_mfma_f32_16x16x32_bf16 v[126:129], v[220:223], v[110:113], v[126:129]
  v_mfma_f32_16x16x32_bf16 v[126:129], v[224:227], v[114:117], v[126:129]
  v_mfma_f32_16x16x32_bf16 v[126:129], v[228:231], v[118:121], v[126:129]
  s_waitcnt lgkmcnt(0)
  v_mfma_f32_16x16x32_bf16 v[130:133], v[216:219], v[138:141], 0
  v_mfma_f32_16x16x32_bf16 v[130:133], v[220:223], v[142:145], v[130:133]
  v_mfma_f32_16x16x32_bf16 v[130:133], v[224:227], v[146:149], v[130:133]
  v_mfma_f32_16x16x32_bf16 v[130:133], v[228:231], v[150:153], v[130:133]
  s_cmp_gt_u32 s6, s65
  s_cbranch_scc1 K_RESTART
  v_pk_fma_f32 v[122:123], v[122:123], s[76:77], v[204:205]
  v_pk_mul_f32 v[156:157], v[122:123], s[4:5]
  v_pk_fma_f32 v[124:125], v[124:125], s[76:77], v[206:207]
  v_pk_mul_f32 v[158:159], v[124:125], s[4:5]
  s_nop 0
  v_pk_fma_f32 v[126:127], v[126:127], s[76:77], v[208:209]
  v_pk_mul_f32 v[160:161], v[126:127], s[4:5]
  v_pk_fma_f32 v[128:129], v[128:129], s[76:77], v[210:211]
  v_pk_mul_f32 v[162:163], v[128:129], s[4:5]
  v_pk_fma_f32 v[130:131], v[130:131], s[76:77], v[212:213]
  v_pk_mul_f32 v[164:165], v[130:131], s[4:5]
  v_pk_fma_f32 v[132:133], v[132:133], s[76:77], v[214:215]
  v_pk_mul_f32 v[166:167], v[132:133], s[4:5]
  v_exp_f32 v156, v156
  v_exp_f32 v157, v157
  v_exp_f32 v158, v158
  v_exp_f32 v159, v159
  v_exp_f32 v160, v160
  v_exp_f32 v161, v161
  v_exp_f32 v162, v162
  v_exp_f32 v163, v163
  v_exp_f32 v164, v164
  v_exp_f32 v165, v165
  v_exp_f32 v166, v166
  v_exp_f32 v167, v167
  v_pk_add_f32 v[156:157], v[156:157], 1.0 op_sel_hi:[1,0]
  v_pk_add_f32 v[158:159], v[158:159], 1.0 op_sel_hi:[1,0]
  v_pk_add_f32 v[160:161], v[160:161], 1.0 op_sel_hi:[1,0]
  v_pk_add_f32 v[162:163], v[162:163], 1.0 op_sel_hi:[1,0]
  v_pk_add_f32 v[164:165], v[164:165], 1.0 op_sel_hi:[1,0]
  v_pk_add_f32 v[166:167], v[166:167], 1.0 op_sel_hi:[1,0]
  v_rcp_f32 v156, v156
  v_rcp_f32 v157, v157
  v_rcp_f32 v158, v158
  v_rcp_f32 v159, v159
  v_rcp_f32 v160, v160
  v_rcp_f32 v161, v161
  v_rcp_f32 v162, v162
  v_rcp_f32 v163, v163
  v_pk_mul_f32 v[122:123], v[122:123], v[156:157]
  v_pk_mul_f32 v[124:125], v[124:125], v[158:159]
  v_cvt_pk_bf16_f32 v172, v122, v123
  v_cvt_pk_bf16_f32 v173, v124, v125
  buffer_store_dwordx2 v[172:173], v7, s[36:39], 0 offen
  v_rcp_f32 v164, v164
  v_rcp_f32 v165, v165
  v_rcp_f32 v166, v166
  v_rcp_f32 v167, v167
  v_pk_mul_f32 v[126:127], v[126:127], v[160:161]
  v_pk_mul_f32 v[128:129], v[128:129], v[162:163]
  v_cvt_pk_bf16_f32 v174, v126, v127
  v_cvt_pk_bf16_f32 v175, v128, v129
  buffer_store_dwordx2 v[174:175], v8, s[36:39], 0 offen
  s_nop 0
  v_pk_mul_f32 v[130:131], v[130:131], v[164:165]
  v_pk_mul_f32 v[132:133], v[132:133], v[166:167]
  v_cvt_pk_bf16_f32 v176, v130, v131
  v_cvt_pk_bf16_f32 v177, v132, v133
  buffer_store_dwordx2 v[176:177], v9, s[36:39], 0 offen
K_END:
  s_endpgm
K_PREP:
  s_sub_u32 s100, s2, 250
  s_lshl_b32 s100, s100, 14
  s_lshl_b32 s101, s3, 12
  s_add_u32 s100, s100, s101
  v_lshlrev_b32 v2, 4, v1
  v_mov_b32 v9, s70
  s_waitcnt vmcnt(10)
  s_barrier
  ds_read_b64_tr_b16 v[90:91], v32 offset:0
  ds_read_b64_tr_b16 v[92:93], v32 offset:1088
  ds_read_b64_tr_b16 v[94:95], v32 offset:8704
  ds_read_b64_tr_b16 v[96:97], v32 offset:9792
  ds_read_b64_tr_b16 v[98:99], v32 offset:17408
  ds_read_b64_tr_b16 v[100:101], v32 offset:18496
  ds_read_b64_tr_b16 v[102:103], v32 offset:26112
  ds_read_b64_tr_b16 v[104:105], v32 offset:27200
  s_waitcnt lgkmcnt(0)
  buffer_store_dwordx4 v[90:93], v2, s[32:35], s100 offen offset:0 sc1
  buffer_store_dwordx4 v[94:97], v2, s[32:35], s100 offen offset:1024 sc1
  buffer_store_dwordx4 v[98:101], v2, s[32:35], s100 offen offset:2048 sc1
  buffer_store_dwordx4 v[102:105], v2, s[32:35], s100 offen offset:3072 sc1
  s_lshr_b32 s100, s3, 2
  s_add_u32 s100, s100, s2
  s_cmp_lg_u32 s100, 250
  s_cbranch_scc1 K_PREPD
  s_mov_b32 s101, 3216550459
  s_lshl_b32 s100, s3, 10
  s_waitcnt vmcnt(6)
  v_lshlrev_b32 v122, 16, v122
  v_mul_f32 v122, s101, v122
  v_lshlrev_b32 v123, 16, v123
  v_mul_f32 v123, s101, v123
  v_lshlrev_b32 v124, 16, v124
  v_mul_f32 v124, s101, v124
  v_lshlrev_b32 v125, 16, v125
  v_mul_f32 v125, s101, v125
  v_lshlrev_b32 v126, 16, v126
  v_mul_f32 v126, s101, v126
  v_lshlrev_b32 v127, 16, v127
  v_mul_f32 v127, s101, v127
  v_lshlrev_b32 v128, 16, v128
  v_mul_f32 v128, s101, v128
  v_lshlrev_b32 v129, 16, v129
  v_mul_f32 v129, s101, v129
  v_cvt_pk_bf16_f32 v130, v122, v123
  v_cvt_pk_bf16_f32 v131, v124, v125
  v_cvt_pk_bf16_f32 v132, v126, v127
  v_cvt_pk_bf16_f32 v133, v128, v129
  v_lshlrev_b32 v4, 16, v130
  v_and_b32 v5, 0xffff0000, v130
  v_sub_f32 v4, v122, v4
  v_sub_f32 v5, v123, v5
  v_cvt_pk_bf16_f32 v134, v4, v5
  v_lshlrev_b32 v4, 16, v131
  v_and_b32 v5, 0xffff0000, v131
  v_sub_f32 v4, v124, v4
  v_sub_f32 v5, v125, v5
  v_cvt_pk_bf16_f32 v135, v4, v5
  v_lshlrev_b32 v4, 16, v132
  v_and_b32 v5, 0xffff0000, v132
  v_sub_f32 v4, v126, v4
  v_sub_f32 v5, v127, v5
  v_cvt_pk_bf16_f32 v136, v4, v5
  v_lshlrev_b32 v4, 16, v133
  v_and_b32 v5, 0xffff0000, v133
  v_sub_f32 v4, v128, v4
  v_sub_f32 v5, v129, v5
  v_cvt_pk_bf16_f32 v137, v4, v5
  s_add_u32 s101, s100, 102400
  s_add_u32 s100, s100, 98304
  buffer_store_dwordx4 v[130:133], v2, s[32:35], s100 offen sc1
  buffer_store_dwordx4 v[134:137], v2, s[32:35], s101 offen sc1
K_PREPD:
  v_lshrrev_b32 v2, 4, v0
  v_lshl_add_u32 v2, v2, 5, v29
  v_add_u32 v2, 75680, v2
  s_waitcnt vmcnt(4)
  ds_write_b128 v2, v[204:207]
  s_mov_b32 exec_lo, s73
  s_mov_b32 exec_hi, s73
  ds_write_b128 v2, v[208:211] offset:9216
  s_mov_b64 exec, -1
  s_sub_u32 s100, s2, 250
  s_lshl_b32 s100, s100, 1
  v_lshl_add_u32 v2, v0, 7, s100
  s_waitcnt vmcnt(0)
  s_barrier
  s_cmp_ge_u32 s3, 4
  s_cbranch_scc1 K_PST
  buffer_store_dword v9, v2, s[44:47], 0 offen sc1
  s_branch K_PST
K_OVF:
  s_waitcnt lgkmcnt(0)
  s_barrier
  s_mul_i32 s101, s2, 10272
  s_add_u32 s101, s101, 64
  v_mov_b32 v7, 21224
  v_mov_b32 v8, -1
  v_cmp_le_u32 vcc, 27, v137
  s_and_b64 exec, exec, vcc
  s_cbranch_execz K_OV0
  v_add_u32 v3, 119968, v132
  ds_read_b32 v3, v3
  s_waitcnt lgkmcnt(0)
  v_cmp_ne_u32 vcc, 28, v3
  s_nop 1
  v_cndmask_b32 v5, v127, v8, vcc
  ds_write_b32 v142, v5 offset:120
  s_and_b64 exec, exec, vcc
  s_cbranch_execz K_OV0
  ds_add_rtn_u32 v3, v7, v28
  v_mov_b32 v196, v127
  v_lshrrev_b32 v197, 2, v132
  s_waitcnt lgkmcnt(0)
  v_lshl_add_u32 v3, v3, 3, s101
  buffer_store_dwordx2 v[196:197], v3, s[40:43], 0 offen sc1
  s_waitcnt vmcnt(0)
K_OV0:
  s_mov_b64 exec, -1
  v_cmp_le_u32 vcc, 27, v138
  s_and_b64 exec, exec, vcc
  s_cbranch_execz K_OV1
  v_add_u32 v3, 119968, v133
  ds_read_b32 v3, v3
  s_waitcnt lgkmcnt(0)
  v_cmp_ne_u32 vcc, 28, v3
  s_nop 1
  v_cndmask_b32 v5, v128, v8, vcc
  ds_write_b32 v143, v5 offset:120
  s_and_b64 exec, exec, vcc
  s_cbranch_execz K_OV1
  ds_add_rtn_u32 v3, v7, v28
  v_mov_b32 v196, v128
  v_lshrrev_b32 v197, 2, v133
  s_waitcnt lgkmcnt(0)
  v_lshl_add_u32 v3, v3, 3, s101
  buffer_store_dwordx2 v[196:197], v3, s[40:43], 0 offen sc1
  s_waitcnt vmcnt(0)
K_OV1:
  s_mov_b64 exec, -1
  v_cmp_le_u32 vcc, 27, v139
  s_and_b64 exec, exec, vcc
  s_cbranch_execz K_OV2
  v_add_u32 v3, 119968, v134
  ds_read_b32 v3, v3
  s_waitcnt lgkmcnt(0)
  v_cmp_ne_u32 vcc, 28, v3
  s_nop 1
  v_cndmask_b32 v5, v129, v8, vcc
  ds_write_b32 v144, v5 offset:120
  s_and_b64 exec, exec, vcc
  s_cbranch_execz K_OV2
  ds_add_rtn_u32 v3, v7, v28
  v_mov_b32 v196, v129
  v_lshrrev_b32 v197, 2, v134
  s_waitcnt lgkmcnt(0)
  v_lshl_add_u32 v3, v3, 3, s101
  buffer_store_dwordx2 v[196:197], v3, s[40:43], 0 offen sc1
  s_waitcnt vmcnt(0)
K_OV2:
  s_mov_b64 exec, -1
  v_cmp_le_u32 vcc, 27, v140
  s_and_b64 exec, exec, vcc
  s_cbranch_execz K_OV3
  v_add_u32 v3, 119968, v135
  ds_read_b32 v3, v3
  s_waitcnt lgkmcnt(0)
  v_cmp_ne_u32 vcc, 28, v3
  s_nop 1
  v_cndmask_b32 v5, v130, v8, vcc
  ds_write_b32 v145, v5 offset:120
  s_and_b64 exec, exec, vcc
  s_cbranch_execz K_OV3
  ds_add_rtn_u32 v3, v7, v28
  v_mov_b32 v196, v130
  v_lshrrev_b32 v197, 2, v135
  s_waitcnt lgkmcnt(0)
  v_lshl_add_u32 v3, v3, 3, s101
  buffer_store_dwordx2 v[196:197], v3, s[40:43], 0 offen sc1
  s_waitcnt vmcnt(0)
K_OV3:
  s_mov_b64 exec, -1
  v_cmp_le_u32 vcc, 27, v141
  s_and_b64 exec, exec, vcc
  s_cbranch_execz K_OV4
  v_add_u32 v3, 119968, v136
  ds_read_b32 v3, v3
  s_waitcnt lgkmcnt(0)
  v_cmp_ne_u32 vcc, 28, v3
  s_nop 1
  v_cndmask_b32 v5, v131, v8, vcc
  ds_write_b32 v146, v5 offset:120
  s_and_b64 exec, exec, vcc
  s_cbranch_execz K_OV4
  ds_add_rtn_u32 v3, v7, v28
  v_mov_b32 v196, v131
  v_lshrrev_b32 v197, 2, v136
  s_waitcnt lgkmcnt(0)
  v_lshl_add_u32 v3, v3, 3, s101
  buffer_store_dwordx2 v[196:197], v3, s[40:43], 0 offen sc1
  s_waitcnt vmcnt(0)
K_OV4:
  s_mov_b64 exec, -1
  s_waitcnt lgkmcnt(0)
  s_barrier
  ds_read_b32 v3, v7
  s_sub_u32 s101, s101, 64
  v_mov_b32 v5, s101
  v_mov_b32 v4, 0
  s_waitcnt lgkmcnt(0)
  buffer_store_dword v3, v5, s[40:43], 0 offen sc1
  s_waitcnt vmcnt(0)
  s_branch K_OVFDONE
K_OX0:
  s_cmp_eq_u32 s63, 0
  s_cbranch_scc1 K_LOOPEND
  v_add_u32 v12, 2048, v12
  v_add_u32 v13, 2048, v13
  v_add_u32 v14, 256, v14
  v_add_u32 v15, 256, v15
  s_branch K_QUAD
.p2align 6
K_QUAD:
  v_mfma_f32_32x32x16_bf16 v[138:153], v[86:89], v[66:69], 0
  v_exp_f32 v156, v122
  v_exp_f32 v157, v123
  v_exp_f32 v158, v124
  v_exp_f32 v159, v125
  v_exp_f32_e64 v160, v126
  v_smfmac_f32_32x32x32_bf16 v[138:153], v[54:57], v[98:105], v58
  v_exp_f32 v161, v127
  v_exp_f32 v162, v128
  v_exp_f32 v163, v129
  v_exp_f32 v172, v130
  v_exp_f32_e64 v173, v131
  v_mfma_f32_32x32x8bf16_1k v[138:153], v[42:43], v[80:81], v[138:153]
  v_exp_f32 v174, v132
  v_exp_f32 v175, v133
  v_exp_f32 v176, v134
  v_exp_f32 v177, v135
  v_exp_f32 v178, v136
  v_exp_f32 v179, v137
  v_pk_add_f32 v[164:165], v[156:157], 1.0 op_sel_hi:[1,0]
  v_pk_add_f32 v[180:181], v[172:173], 1.0 op_sel_hi:[1,0]
  v_pk_add_f32 v[166:167], v[160:161], 1.0 op_sel_hi:[1,0]
  v_pk_add_f32 v[182:183], v[176:177], 1.0 op_sel_hi:[1,0]
  v_mad_u32_u24 v48, v44, s68, v24
  v_mad_u32_u24 v49, v45, s68, v24
  v_mad_u32_u24 v50, v46, s68, v24
  v_mad_u32_u24 v51, v47, s68, v24
  v_pk_fma_f32 v[168:169], v[122:123], v[158:159], v[122:123]
  v_pk_fma_f32 v[184:185], v[130:131], v[174:175], v[130:131]
  v_pk_fma_f32 v[170:171], v[126:127], v[162:163], v[126:127]
  v_pk_fma_f32 v[186:187], v[134:135], v[178:179], v[134:135]
  v_pk_fma_f32 v[156:157], v[164:165], v[158:159], v[164:165]
  v_pk_fma_f32 v[172:173], v[180:181], v[174:175], v[180:181]
  v_pk_fma_f32 v[160:161], v[166:167], v[162:163], v[166:167]
  v_pk_fma_f32 v[176:177], v[182:183], v[178:179], v[182:183]
  v_pk_fma_f32 v[168:169], v[124:125], v[164:165], v[168:169]
  v_pk_fma_f32 v[184:185], v[132:133], v[180:181], v[184:185]
  v_pk_fma_f32 v[170:171], v[128:129], v[166:167], v[170:171]
  v_pk_fma_f32 v[186:187], v[136:137], v[182:183], v[186:187]
  v_pk_mul_f32 v[164:165], v[156:157], v[160:161]
  v_pk_mul_f32 v[180:181], v[172:173], v[176:177]
  v_pk_fma_f32 v[38:39], v[164:165], v[180:181], v[38:39]
  v_pk_mul_f32 v[168:169], v[168:169], v[160:161]
  v_pk_mul_f32 v[184:185], v[184:185], v[176:177]
  v_rcp_f32 v188, v164
  v_rcp_f32 v190, v180
  v_rcp_f32 v189, v165
  v_rcp_f32 v191, v181
  v_pk_fma_f32 v[168:169], v[170:171], v[156:157], v[168:169]
  v_pk_fma_f32 v[184:185], v[186:187], v[172:173], v[184:185]
  v_pk_mul_f32 v[192:193], v[168:169], v[188:189]
  v_pk_mul_f32 v[194:195], v[184:185], v[190:191]
  v_cvt_f64_f32 v[196:197], v192
  v_cvt_f64_f32 v[198:199], v193
  v_cvt_f64_f32 v[200:201], v194
  v_cvt_f64_f32 v[202:203], v195
  ds_add_f64 v48, v[196:197] offset:0
  ds_add_f64 v50, v[198:199] offset:0
  ds_add_f64 v49, v[200:201] offset:0
  ds_add_f64 v51, v[202:203] offset:0
  v_mfma_f32_32x32x16_bf16 v[122:137], v[86:89], v[70:73], 0
  v_exp_f32 v156, v138
  v_exp_f32 v157, v139
  v_exp_f32 v158, v140
  v_exp_f32 v159, v141
  v_exp_f32_e64 v160, v142
  v_smfmac_f32_32x32x32_bf16 v[122:137], v[54:57], v[106:113], v58
  v_exp_f32 v161, v143
  v_exp_f32 v162, v144
  v_exp_f32 v163, v145
  v_exp_f32 v172, v146
  v_exp_f32_e64 v173, v147
  v_mfma_f32_32x32x8bf16_1k v[122:137], v[42:43], v[82:83], v[122:137]
  v_exp_f32 v174, v148
  v_exp_f32 v175, v149
  v_exp_f32 v176, v150
  v_exp_f32 v177, v151
  v_exp_f32 v178, v152
  v_exp_f32 v179, v153
  v_pk_add_f32 v[164:165], v[156:157], 1.0 op_sel_hi:[1,0]
  v_pk_add_f32 v[180:181], v[172:173], 1.0 op_sel_hi:[1,0]
  v_pk_add_f32 v[166:167], v[160:161], 1.0 op_sel_hi:[1,0]
  v_pk_add_f32 v[182:183], v[176:177], 1.0 op_sel_hi:[1,0]
  v_pk_fma_f32 v[168:169], v[138:139], v[158:159], v[138:139]
  v_pk_fma_f32 v[184:185], v[146:147], v[174:175], v[146:147]
  v_pk_fma_f32 v[170:171], v[142:143], v[162:163], v[142:143]
  v_pk_fma_f32 v[186:187], v[150:151], v[178:179], v[150:151]
  ds_read_b64 v[36:37], v12 offset:4096
  ds_read_b32 v34, v14 offset:256
  ds_read_b32 v33, v13 offset:2048
  ds_read_b128 v[44:47], v15 offset:256
  v_pk_fma_f32 v[156:157], v[164:165], v[158:159], v[164:165]
  v_pk_fma_f32 v[172:173], v[180:181], v[174:175], v[180:181]
  v_pk_fma_f32 v[160:161], v[166:167], v[162:163], v[166:167]
  v_pk_fma_f32 v[176:177], v[182:183], v[178:179], v[182:183]
  v_pk_fma_f32 v[168:169], v[140:141], v[164:165], v[168:169]
  v_pk_fma_f32 v[184:185], v[148:149], v[180:181], v[184:185]
  v_pk_fma_f32 v[170:171], v[144:145], v[166:167], v[170:171]
  v_pk_fma_f32 v[186:187], v[152:153], v[182:183], v[186:187]
  v_pk_mul_f32 v[164:165], v[156:157], v[160:161]
  v_pk_mul_f32 v[180:181], v[172:173], v[176:177]
  v_pk_fma_f32 v[38:39], v[164:165], v[180:181], v[38:39]
  v_pk_mul_f32 v[168:169], v[168:169], v[160:161]
  v_pk_mul_f32 v[184:185], v[184:185], v[176:177]
  v_rcp_f32 v188, v164
  v_rcp_f32 v190, v180
  v_rcp_f32 v189, v165
  v_rcp_f32 v191, v181
  v_pk_fma_f32 v[168:169], v[170:171], v[156:157], v[168:169]
  v_pk_fma_f32 v[184:185], v[186:187], v[172:173], v[184:185]
  v_pk_mul_f32 v[192:193], v[168:169], v[188:189]
  v_pk_mul_f32 v[194:195], v[184:185], v[190:191]
  v_cvt_f64_f32 v[196:197], v192
  v_cvt_f64_f32 v[198:199], v193
  v_cvt_f64_f32 v[200:201], v194
  v_cvt_f64_f32 v[202:203], v195
  ds_add_f64 v48, v[196:197] offset:256
  ds_add_f64 v50, v[198:199] offset:256
  ds_add_f64 v49, v[200:201] offset:256
  ds_add_f64 v51, v[202:203] offset:256
  v_mfma_f32_32x32x16_bf16 v[138:153], v[86:89], v[74:77], 0
  v_exp_f32 v156, v122
  v_exp_f32 v157, v123
  v_exp_f32 v158, v124
  v_exp_f32 v159, v125
  v_exp_f32_e64 v160, v126
  v_smfmac_f32_32x32x32_bf16 v[138:153], v[54:57], v[114:121], v58
  v_exp_f32 v161, v127
  v_exp_f32 v162, v128
  v_exp_f32 v163, v129
  v_exp_f32 v172, v130
  v_exp_f32_e64 v173, v131
  v_mfma_f32_32x32x8bf16_1k v[138:153], v[42:43], v[84:85], v[138:153]
  v_exp_f32 v174, v132
  v_exp_f32 v175, v133
  v_exp_f32 v176, v134
  v_exp_f32 v177, v135
  v_exp_f32 v178, v136
  v_exp_f32 v179, v137
  v_pk_add_f32 v[164:165], v[156:157], 1.0 op_sel_hi:[1,0]
  v_pk_add_f32 v[180:181], v[172:173], 1.0 op_sel_hi:[1,0]
  v_pk_add_f32 v[166:167], v[160:161], 1.0 op_sel_hi:[1,0]
  v_pk_add_f32 v[182:183], v[176:177], 1.0 op_sel_hi:[1,0]
  v_pk_fma_f32 v[168:169], v[122:123], v[158:159], v[122:123]
  v_pk_fma_f32 v[184:185], v[130:131], v[174:175], v[130:131]
  v_pk_fma_f32 v[170:171], v[126:127], v[162:163], v[126:127]
  v_pk_fma_f32 v[186:187], v[134:135], v[178:179], v[134:135]
  v_pk_fma_f32 v[156:157], v[164:165], v[158:159], v[164:165]
  v_pk_fma_f32 v[172:173], v[180:181], v[174:175], v[180:181]
  s_waitcnt vmcnt(0) lgkmcnt(4)
  s_nop 0
  v_mad_u32_u24 v32, v34, s69, v23
  ds_read_b64_tr_b16 v[90:91], v19 offset:0
  ds_read_b64_tr_b16 v[92:93], v19 offset:1040
  ds_read_b64_tr_b16 v[94:95], v19 offset:2080
  ds_read_b64_tr_b16 v[96:97], v19 offset:3120
  ds_read_b128 v[86:89], v18
  ds_read_b64_tr_b16 v[98:99], v20 offset:0
  ds_read_b64_tr_b16 v[100:101], v20 offset:1040
  ds_read_b64_tr_b16 v[102:103], v20 offset:2080
  ds_read_b64_tr_b16 v[104:105], v20 offset:3120
  ds_read_b64_tr_b16 v[106:107], v21 offset:0
  ds_read_b64_tr_b16 v[108:109], v21 offset:1040
  ds_read_b64_tr_b16 v[110:111], v21 offset:2080
  ds_read_b64_tr_b16 v[112:113], v21 offset:3120
  ds_read_b64_tr_b16 v[114:115], v22 offset:0
  ds_read_b64_tr_b16 v[116:117], v22 offset:1040
  ds_read_b64_tr_b16 v[118:119], v22 offset:2080
  ds_read_b64_tr_b16 v[120:121], v22 offset:3120
  ds_read_b64_tr_b16 v[78:79], v32 offset:0
  ds_read_b64_tr_b16 v[80:81], v32 offset:64
  ds_read_b64_tr_b16 v[82:83], v32 offset:128
  ds_read_b64_tr_b16 v[84:85], v32 offset:192
  v_lshrrev_b64 v[42:43], v33, v[40:41]
  v_pk_fma_f32 v[160:161], v[166:167], v[162:163], v[166:167]
  v_pk_fma_f32 v[176:177], v[182:183], v[178:179], v[182:183]
  v_pk_fma_f32 v[168:169], v[124:125], v[164:165], v[168:169]
  v_pk_fma_f32 v[184:185], v[132:133], v[180:181], v[184:185]
  v_pk_fma_f32 v[170:171], v[128:129], v[166:167], v[170:171]
  v_pk_fma_f32 v[186:187], v[136:137], v[182:183], v[186:187]
  v_pk_mul_f32 v[164:165], v[156:157], v[160:161]
  v_pk_mul_f32 v[180:181], v[172:173], v[176:177]
  v_pk_fma_f32 v[38:39], v[164:165], v[180:181], v[38:39]
  v_pk_mul_f32 v[168:169], v[168:169], v[160:161]
  v_pk_mul_f32 v[184:185], v[184:185], v[176:177]
  v_rcp_f32 v188, v164
  v_rcp_f32 v190, v180
  v_rcp_f32 v189, v165
  v_rcp_f32 v191, v181
  v_pk_fma_f32 v[168:169], v[170:171], v[156:157], v[168:169]
  v_pk_fma_f32 v[184:185], v[186:187], v[172:173], v[184:185]
  v_pk_mul_f32 v[192:193], v[168:169], v[188:189]
  v_pk_mul_f32 v[194:195], v[184:185], v[190:191]
  v_cvt_f64_f32 v[196:197], v192
  v_cvt_f64_f32 v[198:199], v193
  v_cvt_f64_f32 v[200:201], v194
  v_cvt_f64_f32 v[202:203], v195
  ds_add_f64 v48, v[196:197] offset:512
  ds_add_f64 v50, v[198:199] offset:512
  ds_add_f64 v49, v[200:201] offset:512
  ds_add_f64 v51, v[202:203] offset:512
  s_waitcnt lgkmcnt(4)
  s_nop 0
  v_mfma_f32_32x32x16_bf16 v[122:137], v[86:89], v[62:65], 0
  v_exp_f32 v156, v138
  v_exp_f32 v157, v139
  v_exp_f32 v158, v140
  v_exp_f32 v159, v141
  v_exp_f32 v160, v142
  s_add_u32 m0, s62, 0
  v_add_u32_dpp v52, v36, v10 row_newbcast:0 row_mask:0xf bank_mask:0xf
  buffer_load_dwordx4 v52, s[20:23], 0 offen sc1 lds
  s_add_u32 m0, s62, 1040
  v_add_u32_dpp v53, v36, v10 row_newbcast:2 row_mask:0xf bank_mask:0xf
  buffer_load_dwordx4 v53, s[20:23], 0 offen sc1 lds
  v_smfmac_f32_32x32x32_bf16 v[122:137], v[54:57], v[90:97], v58
  v_exp_f32 v161, v143
  v_exp_f32 v162, v144
  v_exp_f32 v163, v145
  v_exp_f32 v172, v146
  v_exp_f32_e64 v173, v147
  s_add_u32 m0, s62, 2080
  v_add_u32_dpp v52, v36, v10 row_newbcast:4 row_mask:0xf bank_mask:0xf
  buffer_load_dwordx4 v52, s[20:23], 0 offen sc1 lds
  s_add_u32 m0, s62, 3120
  v_add_u32_dpp v53, v36, v10 row_newbcast:6 row_mask:0xf bank_mask:0xf
  buffer_load_dwordx4 v53, s[20:23], 0 offen sc1 lds
  v_mfma_f32_32x32x8bf16_1k v[122:137], v[42:43], v[78:79], v[122:137]
  v_exp_f32 v174, v148
  v_exp_f32 v175, v149
  v_exp_f32 v176, v150
  v_exp_f32 v177, v151
  v_exp_f32 v178, v152
  v_exp_f32 v179, v153
  s_add_u32 m0, s62, 4160
  v_add_u32_dpp v52, v36, v10 row_newbcast:8 row_mask:0xf bank_mask:0xf
  buffer_load_dwordx4 v52, s[20:23], 0 offen sc1 lds
  s_add_u32 m0, s62, 5200
  v_add_u32_dpp v53, v36, v10 row_newbcast:10 row_mask:0xf bank_mask:0xf
  buffer_load_dwordx4 v53, s[20:23], 0 offen sc1 lds
  s_add_u32 m0, s62, 6240
  v_add_u32_dpp v52, v36, v10 row_newbcast:12 row_mask:0xf bank_mask:0xf
  buffer_load_dwordx4 v52, s[20:23], 0 offen sc1 lds
  s_add_u32 m0, s62, 7280
  v_add_u32_dpp v53, v36, v10 row_newbcast:14 row_mask:0xf bank_mask:0xf
  buffer_load_dwordx4 v53, s[20:23], 0 offen sc1 lds
  s_add_u32 m0, s62, 8320
  v_add_u32_e64 v52, v37, v11
  buffer_load_dwordx4 v52, s[24:27], 0 offen  lds
  v_pk_add_f32 v[164:165], v[156:157], 1.0 op_sel_hi:[1,0]
  v_pk_add_f32 v[180:181], v[172:173], 1.0 op_sel_hi:[1,0]
  v_pk_add_f32 v[166:167], v[160:161], 1.0 op_sel_hi:[1,0]
  v_pk_add_f32 v[182:183], v[176:177], 1.0 op_sel_hi:[1,0]
  v_pk_fma_f32 v[168:169], v[138:139], v[158:159], v[138:139]
  v_pk_fma_f32 v[184:185], v[146:147], v[174:175], v[146:147]
  v_pk_fma_f32 v[170:171], v[142:143], v[162:163], v[142:143]
  v_pk_fma_f32 v[186:187], v[150:151], v[178:179], v[150:151]
  v_pk_fma_f32 v[156:157], v[164:165], v[158:159], v[164:165]
  v_pk_fma_f32 v[172:173], v[180:181], v[174:175], v[180:181]
  v_pk_fma_f32 v[160:161], v[166:167], v[162:163], v[166:167]
  v_pk_fma_f32 v[176:177], v[182:183], v[178:179], v[182:183]
  v_pk_fma_f32 v[168:169], v[140:141], v[164:165], v[168:169]
  v_pk_fma_f32 v[184:185], v[148:149], v[180:181], v[184:185]
  v_pk_fma_f32 v[170:171], v[144:145], v[166:167], v[170:171]
  v_pk_fma_f32 v[186:187], v[152:153], v[182:183], v[186:187]
  v_pk_mul_f32 v[164:165], v[156:157], v[160:161]
  v_pk_mul_f32 v[180:181], v[172:173], v[176:177]
  v_pk_fma_f32 v[38:39], v[164:165], v[180:181], v[38:39]
  v_pk_mul_f32 v[168:169], v[168:169], v[160:161]
  v_pk_mul_f32 v[184:185], v[184:185], v[176:177]
  v_rcp_f32 v188, v164
  v_rcp_f32 v190, v180
  v_rcp_f32 v189, v165
  v_rcp_f32 v191, v181
  v_pk_fma_f32 v[168:169], v[170:171], v[156:157], v[168:169]
  v_pk_fma_f32 v[184:185], v[186:187], v[172:173], v[184:185]
  v_pk_mul_f32 v[192:193], v[168:169], v[188:189]
  v_pk_mul_f32 v[194:195], v[184:185], v[190:191]
  v_add_u32 v12, 2048, v12
  v_add_u32 v13, 2048, v13
  v_add_u32 v14, 256, v14
  v_add_u32 v15, 256, v15
  v_cvt_f64_f32 v[196:197], v192
  v_cvt_f64_f32 v[198:199], v193
  v_cvt_f64_f32 v[200:201], v194
  v_cvt_f64_f32 v[202:203], v195
  ds_add_f64 v48, v[196:197] offset:768
  ds_add_f64 v50, v[198:199] offset:768
  ds_add_f64 v49, v[200:201] offset:768
  ds_add_f64 v51, v[202:203] offset:768
  s_sub_u32 s63, s63, 1
  s_cmp_lg_u32 s63, 0
  s_cbranch_scc1 K_QUAD
  s_branch K_LOOPEND
K_TEXTEND:
.p2align 6
K_SAFE:
  v_mfma_f32_32x32x16_bf16 v[138:153], v[86:89], v[66:69], 0
  v_exp_f32 v156, v122
  v_exp_f32 v157, v123
  v_exp_f32 v158, v124
  v_exp_f32 v159, v125
  v_exp_f32_e64 v160, v126
  v_smfmac_f32_32x32x32_bf16 v[138:153], v[54:57], v[98:105], v58
  v_exp_f32 v161, v127
  v_exp_f32 v162, v128
  v_exp_f32 v163, v129
  v_exp_f32 v172, v130
  v_exp_f32_e64 v173, v131
  v_mfma_f32_32x32x8bf16_1k v[138:153], v[42:43], v[80:81], v[138:153]
  v_exp_f32 v174, v132
  v_exp_f32 v175, v133
  v_exp_f32 v176, v134
  v_exp_f32 v177, v135
  v_exp_f32 v178, v136
  v_exp_f32 v179, v137
  v_pk_add_f32 v[156:157], v[156:157], 1.0 op_sel_hi:[1,0]
  v_pk_add_f32 v[172:173], v[172:173], 1.0 op_sel_hi:[1,0]
  v_pk_add_f32 v[158:159], v[158:159], 1.0 op_sel_hi:[1,0]
  v_pk_add_f32 v[174:175], v[174:175], 1.0 op_sel_hi:[1,0]
  v_mad_u32_u24 v48, v44, s68, v24
  v_mad_u32_u24 v49, v45, s68, v24
  v_mad_u32_u24 v50, v46, s68, v24
  v_mad_u32_u24 v51, v47, s68, v24
  v_pk_add_f32 v[160:161], v[160:161], 1.0 op_sel_hi:[1,0]
  v_pk_add_f32 v[176:177], v[176:177], 1.0 op_sel_hi:[1,0]
  v_pk_add_f32 v[162:163], v[162:163], 1.0 op_sel_hi:[1,0]
  v_pk_add_f32 v[178:179], v[178:179], 1.0 op_sel_hi:[1,0]
  v_rcp_f32 v164, v156
  v_rcp_f32 v180, v172
  v_rcp_f32 v165, v157
  v_rcp_f32 v181, v173
  v_rcp_f32 v166, v158
  v_rcp_f32 v182, v174
  v_rcp_f32 v167, v159
  v_rcp_f32 v183, v175
  v_rcp_f32 v168, v160
  v_rcp_f32 v184, v176
  v_rcp_f32 v169, v161
  v_rcp_f32 v185, v177
  v_rcp_f32 v170, v162
  v_rcp_f32 v186, v178
  v_rcp_f32 v171, v163
  v_rcp_f32 v187, v179
  v_pk_mul_f32 v[192:193], v[122:123], v[164:165]
  v_pk_mul_f32 v[194:195], v[130:131], v[180:181]
  v_pk_fma_f32 v[192:193], v[124:125], v[166:167], v[192:193]
  v_pk_fma_f32 v[194:195], v[132:133], v[182:183], v[194:195]
  v_pk_fma_f32 v[192:193], v[126:127], v[168:169], v[192:193]
  v_pk_fma_f32 v[194:195], v[134:135], v[184:185], v[194:195]
  v_pk_fma_f32 v[192:193], v[128:129], v[170:171], v[192:193]
  v_pk_fma_f32 v[194:195], v[136:137], v[186:187], v[194:195]
  v_cvt_f64_f32 v[196:197], v192
  v_cvt_f64_f32 v[198:199], v193
  v_cvt_f64_f32 v[200:201], v194
  v_cvt_f64_f32 v[202:203], v195
  ds_add_f64 v48, v[196:197] offset:0
  ds_add_f64 v50, v[198:199] offset:0
  ds_add_f64 v49, v[200:201] offset:0
  ds_add_f64 v51, v[202:203] offset:0
  v_mfma_f32_32x32x16_bf16 v[122:137], v[86:89], v[70:73], 0
  v_exp_f32 v156, v138
  v_exp_f32 v157, v139
  v_exp_f32 v158, v140
  v_exp_f32 v159, v141
  v_exp_f32_e64 v160, v142
  v_smfmac_f32_32x32x32_bf16 v[122:137], v[54:57], v[106:113], v58
  v_exp_f32 v161, v143
  v_exp_f32 v162, v144
  v_exp_f32 v163, v145
  v_exp_f32 v172, v146
  v_exp_f32_e64 v173, v147
  v_mfma_f32_32x32x8bf16_1k v[122:137], v[42:43], v[82:83], v[122:137]
  v_exp_f32 v174, v148
  v_exp_f32 v175, v149
  v_exp_f32 v176, v150
  v_exp_f32 v177, v151
  v_exp_f32 v178, v152
  v_exp_f32 v179, v153
  v_pk_add_f32 v[156:157], v[156:157], 1.0 op_sel_hi:[1,0]
  v_pk_add_f32 v[172:173], v[172:173], 1.0 op_sel_hi:[1,0]
  v_pk_add_f32 v[158:159], v[158:159], 1.0 op_sel_hi:[1,0]
  v_pk_add_f32 v[174:175], v[174:175], 1.0 op_sel_hi:[1,0]
  v_pk_add_f32 v[160:161], v[160:161], 1.0 op_sel_hi:[1,0]
  v_pk_add_f32 v[176:177], v[176:177], 1.0 op_sel_hi:[1,0]
  v_pk_add_f32 v[162:163], v[162:163], 1.0 op_sel_hi:[1,0]
  v_pk_add_f32 v[178:179], v[178:179], 1.0 op_sel_hi:[1,0]
  ds_read_b64 v[36:37], v12 offset:4096
  ds_read_b32 v34, v14 offset:256
  ds_read_b32 v33, v13 offset:2048
  ds_read_b128 v[44:47], v15 offset:256
  v_rcp_f32 v164, v156
  v_rcp_f32 v180, v172
  v_rcp_f32 v165, v157
  v_rcp_f32 v181, v173
  v_rcp_f32 v166, v158
  v_rcp_f32 v182, v174
  v_rcp_f32 v167, v159
  v_rcp_f32 v183, v175
  v_rcp_f32 v168, v160
  v_rcp_f32 v184, v176
  v_rcp_f32 v169, v161
  v_rcp_f32 v185, v177
  v_rcp_f32 v170, v162
  v_rcp_f32 v186, v178
  v_rcp_f32 v171, v163
  v_rcp_f32 v187, v179
  v_pk_mul_f32 v[192:193], v[138:139], v[164:165]
  v_pk_mul_f32 v[194:195], v[146:147], v[180:181]
  v_pk_fma_f32 v[192:193], v[140:141], v[166:167], v[192:193]
  v_pk_fma_f32 v[194:195], v[148:149], v[182:183], v[194:195]
  v_pk_fma_f32 v[192:193], v[142:143], v[168:169], v[192:193]
  v_pk_fma_f32 v[194:195], v[150:151], v[184:185], v[194:195]
  v_pk_fma_f32 v[192:193], v[144:145], v[170:171], v[192:193]
  v_pk_fma_f32 v[194:195], v[152:153], v[186:187], v[194:195]
  v_cvt_f64_f32 v[196:197], v192
  v_cvt_f64_f32 v[198:199], v193
  v_cvt_f64_f32 v[200:201], v194
  v_cvt_f64_f32 v[202:203], v195
  ds_add_f64 v48, v[196:197] offset:256
  ds_add_f64 v50, v[198:199] offset:256
  ds_add_f64 v49, v[200:201] offset:256
  ds_add_f64 v51, v[202:203] offset:256
  v_mfma_f32_32x32x16_bf16 v[138:153], v[86:89], v[74:77], 0
  v_exp_f32 v156, v122
  v_exp_f32 v157, v123
  v_exp_f32 v158, v124
  v_exp_f32 v159, v125
  v_exp_f32_e64 v160, v126
  v_smfmac_f32_32x32x32_bf16 v[138:153], v[54:57], v[114:121], v58
  v_exp_f32 v161, v127
  v_exp_f32 v162, v128
  v_exp_f32 v163, v129
  v_exp_f32 v172, v130
  v_exp_f32_e64 v173, v131
  v_mfma_f32_32x32x8bf16_1k v[138:153], v[42:43], v[84:85], v[138:153]
  v_exp_f32 v174, v132
  v_exp_f32 v175, v133
  v_exp_f32 v176, v134
  v_exp_f32 v177, v135
  v_exp_f32 v178, v136
  v_exp_f32 v179, v137
  v_pk_add_f32 v[156:157], v[156:157], 1.0 op_sel_hi:[1,0]
  v_pk_add_f32 v[172:173], v[172:173], 1.0 op_sel_hi:[1,0]
  v_pk_add_f32 v[158:159], v[158:159], 1.0 op_sel_hi:[1,0]
  v_pk_add_f32 v[174:175], v[174:175], 1.0 op_sel_hi:[1,0]
  v_pk_add_f32 v[160:161], v[160:161], 1.0 op_sel_hi:[1,0]
  v_pk_add_f32 v[176:177], v[176:177], 1.0 op_sel_hi:[1,0]
  v_pk_add_f32 v[162:163], v[162:163], 1.0 op_sel_hi:[1,0]
  v_pk_add_f32 v[178:179], v[178:179], 1.0 op_sel_hi:[1,0]
  v_rcp_f32_e64 v164, v156
  v_rcp_f32 v180, v172
  s_waitcnt vmcnt(0) lgkmcnt(4)
  v_mad_u32_u24 v32, v34, s69, v23
  ds_read_b64_tr_b16 v[90:91], v19 offset:0
  ds_read_b64_tr_b16 v[92:93], v19 offset:1040
  ds_read_b64_tr_b16 v[94:95], v19 offset:2080
  ds_read_b64_tr_b16 v[96:97], v19 offset:3120
  ds_read_b128 v[86:89], v18
  ds_read_b64_tr_b16 v[98:99], v20 offset:0
  ds_read_b64_tr_b16 v[100:101], v20 offset:1040
  ds_read_b64_tr_b16 v[102:103], v20 offset:2080
  ds_read_b64_tr_b16 v[104:105], v20 offset:3120
  ds_read_b64_tr_b16 v[106:107], v21 offset:0
  ds_read_b64_tr_b16 v[108:109], v21 offset:1040
  ds_read_b64_tr_b16 v[110:111], v21 offset:2080
  ds_read_b64_tr_b16 v[112:113], v21 offset:3120
  ds_read_b64_tr_b16 v[114:115], v22 offset:0
  ds_read_b64_tr_b16 v[116:117], v22 offset:1040
  ds_read_b64_tr_b16 v[118:119], v22 offset:2080
  ds_read_b64_tr_b16 v[120:121], v22 offset:3120
  ds_read_b64_tr_b16 v[78:79], v32 offset:0
  ds_read_b64_tr_b16 v[80:81], v32 offset:64
  ds_read_b64_tr_b16 v[82:83], v32 offset:128
  ds_read_b64_tr_b16 v[84:85], v32 offset:192
  v_lshrrev_b64 v[42:43], v33, v[40:41]
  v_rcp_f32 v165, v157
  v_rcp_f32 v181, v173
  v_rcp_f32 v166, v158
  v_rcp_f32 v182, v174
  v_rcp_f32 v167, v159
  v_rcp_f32 v183, v175
  v_rcp_f32 v168, v160
  v_rcp_f32 v184, v176
  v_rcp_f32 v169, v161
  v_rcp_f32 v185, v177
  v_rcp_f32 v170, v162
  v_rcp_f32 v186, v178
  v_rcp_f32 v171, v163
  v_rcp_f32 v187, v179
  v_pk_mul_f32 v[192:193], v[122:123], v[164:165]
  v_pk_mul_f32 v[194:195], v[130:131], v[180:181]
  v_pk_fma_f32 v[192:193], v[124:125], v[166:167], v[192:193]
  v_pk_fma_f32 v[194:195], v[132:133], v[182:183], v[194:195]
  v_pk_fma_f32 v[192:193], v[126:127], v[168:169], v[192:193]
  v_pk_fma_f32 v[194:195], v[134:135], v[184:185], v[194:195]
  v_pk_fma_f32 v[192:193], v[128:129], v[170:171], v[192:193]
  v_pk_fma_f32 v[194:195], v[136:137], v[186:187], v[194:195]
  v_cvt_f64_f32 v[196:197], v192
  v_cvt_f64_f32 v[198:199], v193
  v_cvt_f64_f32 v[200:201], v194
  v_cvt_f64_f32 v[202:203], v195
  ds_add_f64 v48, v[196:197] offset:512
  ds_add_f64 v50, v[198:199] offset:512
  ds_add_f64 v49, v[200:201] offset:512
  ds_add_f64 v51, v[202:203] offset:512
  s_waitcnt lgkmcnt(4)
  s_nop 0
  v_mfma_f32_32x32x16_bf16 v[122:137], v[86:89], v[62:65], 0
  v_exp_f32 v156, v138
  v_exp_f32 v157, v139
  v_exp_f32 v158, v140
  v_exp_f32 v159, v141
  v_exp_f32 v160, v142
  s_add_u32 m0, s62, 0
  v_add_u32_dpp v52, v36, v10 row_newbcast:0 row_mask:0xf bank_mask:0xf
  buffer_load_dwordx4 v52, s[20:23], 0 offen sc1 lds
  s_add_u32 m0, s62, 1040
  v_add_u32_dpp v53, v36, v10 row_newbcast:2 row_mask:0xf bank_mask:0xf
  buffer_load_dwordx4 v53, s[20:23], 0 offen sc1 lds
  v_smfmac_f32_32x32x32_bf16 v[122:137], v[54:57], v[90:97], v58
  v_exp_f32 v161, v143
  v_exp_f32 v162, v144
  v_exp_f32 v163, v145
  v_exp_f32 v172, v146
  v_exp_f32_e64 v173, v147
  s_add_u32 m0, s62, 2080
  v_add_u32_dpp v52, v36, v10 row_newbcast:4 row_mask:0xf bank_mask:0xf
  buffer_load_dwordx4 v52, s[20:23], 0 offen sc1 lds
  s_add_u32 m0, s62, 3120
  v_add_u32_dpp v53, v36, v10 row_newbcast:6 row_mask:0xf bank_mask:0xf
  buffer_load_dwordx4 v53, s[20:23], 0 offen sc1 lds
  v_mfma_f32_32x32x8bf16_1k v[122:137], v[42:43], v[78:79], v[122:137]
  v_exp_f32 v174, v148
  v_exp_f32 v175, v149
  v_exp_f32 v176, v150
  v_exp_f32 v177, v151
  v_exp_f32 v178, v152
  v_exp_f32 v179, v153
  s_add_u32 m0, s62, 4160
  v_add_u32_dpp v52, v36, v10 row_newbcast:8 row_mask:0xf bank_mask:0xf
  buffer_load_dwordx4 v52, s[20:23], 0 offen sc1 lds
  s_add_u32 m0, s62, 5200
  v_add_u32_dpp v53, v36, v10 row_newbcast:10 row_mask:0xf bank_mask:0xf
  buffer_load_dwordx4 v53, s[20:23], 0 offen sc1 lds
  s_add_u32 m0, s62, 6240
  v_add_u32_dpp v52, v36, v10 row_newbcast:12 row_mask:0xf bank_mask:0xf
  buffer_load_dwordx4 v52, s[20:23], 0 offen sc1 lds
  s_add_u32 m0, s62, 7280
  v_add_u32_dpp v53, v36, v10 row_newbcast:14 row_mask:0xf bank_mask:0xf
  buffer_load_dwordx4 v53, s[20:23], 0 offen sc1 lds
  s_add_u32 m0, s62, 8320
  v_add_u32_e64 v52, v37, v11
  buffer_load_dwordx4 v52, s[24:27], 0 offen  lds
  v_pk_add_f32 v[156:157], v[156:157], 1.0 op_sel_hi:[1,0]
  v_pk_add_f32 v[172:173], v[172:173], 1.0 op_sel_hi:[1,0]
  v_pk_add_f32 v[158:159], v[158:159], 1.0 op_sel_hi:[1,0]
  v_pk_add_f32 v[174:175], v[174:175], 1.0 op_sel_hi:[1,0]
  v_pk_add_f32 v[160:161], v[160:161], 1.0 op_sel_hi:[1,0]
  v_pk_add_f32 v[176:177], v[176:177], 1.0 op_sel_hi:[1,0]
  v_pk_add_f32 v[162:163], v[162:163], 1.0 op_sel_hi:[1,0]
  v_pk_add_f32 v[178:179], v[178:179], 1.0 op_sel_hi:[1,0]
  v_rcp_f32 v164, v156
  v_rcp_f32 v180, v172
  v_rcp_f32 v165, v157
  v_rcp_f32 v181, v173
  v_rcp_f32 v166, v158
  v_rcp_f32 v182, v174
  v_rcp_f32 v167, v159
  v_rcp_f32 v183, v175
  v_rcp_f32 v168, v160
  v_rcp_f32 v184, v176
  v_rcp_f32 v169, v161
  v_rcp_f32 v185, v177
  v_rcp_f32 v170, v162
  v_rcp_f32 v186, v178
  v_rcp_f32 v171, v163
  v_rcp_f32 v187, v179
  v_pk_mul_f32 v[192:193], v[138:139], v[164:165]
  v_pk_mul_f32 v[194:195], v[146:147], v[180:181]
  v_pk_fma_f32 v[192:193], v[140:141], v[166:167], v[192:193]
  v_pk_fma_f32 v[194:195], v[148:149], v[182:183], v[194:195]
  v_pk_fma_f32 v[192:193], v[142:143], v[168:169], v[192:193]
  v_pk_fma_f32 v[194:195], v[150:151], v[184:185], v[194:195]
  v_pk_fma_f32 v[192:193], v[144:145], v[170:171], v[192:193]
  v_pk_fma_f32 v[194:195], v[152:153], v[186:187], v[194:195]
  v_add_u32 v12, 2048, v12
  v_add_u32 v13, 2048, v13
  v_add_u32 v14, 256, v14
  v_add_u32 v15, 256, v15
  v_cvt_f64_f32 v[196:197], v192
  v_cvt_f64_f32 v[198:199], v193
  v_cvt_f64_f32 v[200:201], v194
  v_cvt_f64_f32 v[202:203], v195
  ds_add_f64 v48, v[196:197] offset:768
  ds_add_f64 v50, v[198:199] offset:768
  ds_add_f64 v49, v[200:201] offset:768
  ds_add_f64 v51, v[202:203] offset:768
  s_sub_u32 s63, s63, 1
  s_cmp_lg_u32 s63, 0
  s_cbranch_scc1 K_SAFE
  s_branch K_LOOPEND
K_CPOLLW:
  s_waitcnt vmcnt(1)
  s_cmp_eq_u32 s53, 3
  s_cbranch_scc1 K_CPOLLC
  s_waitcnt vmcnt(0)
  s_branch K_CPOLLC
K_CAGAIN:
  s_cmp_lg_u64 s[50:51], 0
  s_cbranch_scc1 K_CA2
  s_cmp_lg_u32 s54, 0
  s_cbranch_scc1 K_CA2
  s_mov_b32 s54, 1
  buffer_load_dwordx4 v[156:159], v31, s[32:35], s4 offen offset:0 sc1
  buffer_load_dwordx4 v[160:163], v31, s[32:35], s4 offen offset:1024 sc1
  buffer_load_dwordx4 v[164:167], v31, s[32:35], s4 offen offset:2048 sc1
  buffer_load_dwordx4 v[168:171], v31, s[32:35], s4 offen offset:3072 sc1
  buffer_load_dwordx4 v[172:175], v31, s[32:35], s5 offen offset:0 sc1
  buffer_load_dwordx4 v[176:179], v31, s[32:35], s5 offen offset:1024 sc1
  buffer_load_dwordx4 v[180:183], v31, s[32:35], s5 offen offset:2048 sc1
  buffer_load_dwordx4 v[184:187], v31, s[32:35], s5 offen offset:3072 sc1
  buffer_load_dwordx4 v[62:65], v31, s[32:35], s6 offen offset:0 sc1
  buffer_load_dwordx4 v[66:69], v31, s[32:35], s6 offen offset:1024 sc1
  buffer_load_dwordx4 v[70:73], v31, s[32:35], s6 offen offset:2048 sc1
  buffer_load_dwordx4 v[74:77], v31, s[32:35], s6 offen offset:3072 sc1
K_CA2:
  s_sleep 2
  s_cmp_lt_u32 s100, 0x8000
  s_cbranch_scc1 K_CPOLL
  s_branch K_CPOLLD
K_MARK:
  s_and_saveexec_b64 s[74:75], vcc
  v_lshrrev_b32 v2, 2, v0
  v_lshrrev_b32 v3, 5, v2
  v_lshlrev_b32 v3, 2, v3
  v_lshlrev_b32 v2, v2, v28
  ds_or_b32 v3, v2 offset:21248
  v_mov_b32 v128, 0
  s_mov_b64 exec, s[74:75]
  s_branch K_NOMARK
K_S0AX:
  buffer_load_dword v237, v238, s[44:47], 0 offen sc1
  s_branch K_S0A
K_S0BX:
  s_nop 0
  s_branch K_S0B
K_WLATE:
  s_mov_b32 s54, 1
  buffer_load_dwordx4 v[156:159], v31, s[32:35], s4 offen offset:0 sc1
  buffer_load_dwordx4 v[160:163], v31, s[32:35], s4 offen offset:1024 sc1
  buffer_load_dwordx4 v[164:167], v31, s[32:35], s4 offen offset:2048 sc1
  buffer_load_dwordx4 v[168:171], v31, s[32:35], s4 offen offset:3072 sc1
  buffer_load_dwordx4 v[172:175], v31, s[32:35], s5 offen offset:0 sc1
  buffer_load_dwordx4 v[176:179], v31, s[32:35], s5 offen offset:1024 sc1
  buffer_load_dwordx4 v[180:183], v31, s[32:35], s5 offen offset:2048 sc1
  buffer_load_dwordx4 v[184:187], v31, s[32:35], s5 offen offset:3072 sc1
  buffer_load_dwordx4 v[62:65], v31, s[32:35], s6 offen offset:0 sc1
  buffer_load_dwordx4 v[66:69], v31, s[32:35], s6 offen offset:1024 sc1
  buffer_load_dwordx4 v[70:73], v31, s[32:35], s6 offen offset:2048 sc1
  buffer_load_dwordx4 v[74:77], v31, s[32:35], s6 offen offset:3072 sc1
  s_waitcnt vmcnt(0) lgkmcnt(0)
  s_branch K_WOK
K_DLATER:
  s_cmp_eq_u32 s54, 0
  s_cbranch_scc1 K_WLATE
  s_waitcnt vmcnt(0) lgkmcnt(0)
  s_branch K_WOK
K_NOGEMM0:
  s_waitcnt vmcnt(0)
  s_branch K_NOGEMM
K_RESTART:
  s_mov_b32 s65, 1
  s_mov_b32 s66, 0
  s_waitcnt lgkmcnt(0)
  s_barrier
  v_mov_b32 v196, 0
  v_mov_b32 v197, 0
  v_mov_b32 v198, 0
  v_mov_b32 v199, 0
  ds_write_b128 v29, v[196:199] offset:21280
  ds_write_b128 v29, v[196:199] offset:29472
  ds_write_b128 v29, v[196:199] offset:37664
  ds_write_b128 v29, v[196:199] offset:45856
  ds_write_b128 v29, v[196:199] offset:54048
  v_cmp_gt_u32 vcc, 40, v0
  s_and_saveexec_b64 s[74:75], vcc
  ds_write_b128 v29, v[196:199] offset:62240
  s_mov_b64 exec, s[74:75]
  s_branch K_RELOAD
K_SPLIT:
  s_mov_b32 s66, 1
  s_waitcnt lgkmcnt(0)
  s_barrier
  s_branch K_RELOAD
K_NEXT:
  s_cmp_eq_u32 s66, 4
  s_cbranch_scc1 K_NEXTOV
  s_cmp_eq_u32 s66, 3
  s_cbranch_scc1 K_OVPART1
  s_cmp_eq_u32 s66, 2
  s_cbranch_scc1 K_CELLSDONE
  s_mov_b32 s66, 2
K_RELOAD:
  v_lshrrev_b32 v3, 2, v0
  s_mov_b32 s100, 81920
  v_mul_u32_u24 v27, s100, v3
  s_waitcnt vmcnt(0)
  buffer_load_dwordx4 v[122:125], v30, s[28:31], 0 offen offset:0 sc1
  buffer_load_dwordx4 v[126:129], v30, s[28:31], 0 offen offset:64 sc1
  s_waitcnt vmcnt(0)
  s_mov_b32 exec_lo, 0xaaaaaaaa
  s_mov_b32 exec_hi, 0xaaaaaaaa
  v_mov_b32 v125, 0
  v_mov_b32 v129, 0
  s_mov_b64 exec, -1
  s_cmp_eq_u32 s66, 0
  s_cbranch_scc1 K_ROUND
  s_lshr_b32 s100, s3, 2
  s_add_u32 s100, s100, 1
  s_cmp_eq_u32 s100, s66
  s_cbranch_scc1 K_ROUND
  v_mov_b32 v122, 0
  v_mov_b32 v123, 0
  v_mov_b32 v124, 0
  v_mov_b32 v125, 0
  v_mov_b32 v126, 0
  v_mov_b32 v127, 0
  v_mov_b32 v128, 0
  v_mov_b32 v129, 0
K_ROUND:
  v_mov_b32 v196, 0
  v_mov_b32 v197, 0
  v_mov_b32 v198, 0
  v_mov_b32 v199, 0
  v_cmp_gt_u32 vcc, 190, v0
  s_and_saveexec_b64 s[74:75], vcc
  ds_write_b128 v29, v[196:199] offset:18176
  s_mov_b64 exec, s[74:75]
  v_mov_b32 v200, 2147483711
  v_mov_b32 v201, 2147483648
  v_mov_b32 v202, 2147483711
  v_mov_b32 v203, 2147483648
  ds_write_b128 v29, v[200:203]
  ds_write_b128 v29, v[200:203] offset:8192
  v_cmp_gt_u32 vcc, 112, v0
  s_and_saveexec_b64 s[74:75], vcc
  ds_write_b128 v29, v[200:203] offset:16384
  s_mov_b64 exec, s[74:75]
  v_and_b32 v12, 2047, v12
  v_and_b32 v13, 2047, v13
  v_subrev_u32 v15, 18176, v15
  v_and_b32 v15, 255, v15
  v_add_u32 v15, 18176, v15
  v_and_b32 v4, 12, v1
  v_add_u32 v14, v15, v4
  s_waitcnt lgkmcnt(0)
  s_barrier
  s_branch K_PHASE1
K_STARTOV:
  v_readfirstlane_b32 s48, v196
  v_readfirstlane_b32 s49, v197
  v_readfirstlane_b32 s50, v198
  v_readfirstlane_b32 s51, v199
  s_mov_b32 s66, 4
  s_waitcnt lgkmcnt(0)
K_NEXTOV:
  s_ff1_i32_b64 s71, s[48:49]
  s_cmp_eq_u32 s71, -1
  s_cbranch_scc1 K_OVN0
  s_bitset0_b64 s[48:49], s71
  s_add_u32 s71, s71, 0
  s_branch K_OVGO
K_OVN0:
  s_ff1_i32_b64 s71, s[50:51]
  s_cmp_eq_u32 s71, -1
  s_cbranch_scc1 K_OVN1
  s_bitset0_b64 s[50:51], s71
  s_add_u32 s71, s71, 64
  s_branch K_OVGO
K_OVN1:
  s_branch K_CONV
K_OVGO:
  s_mov_b32 s66, 3
  v_mov_b32 v6, v0
  s_branch K_OVLD
K_OVPART1:
  s_mov_b32 s66, 4
  v_add_u32 v6, 2048, v0
K_OVLD:
  s_mul_i32 s100, s71, 20544
  s_mul_i32 s101, s71, 81920
  v_mov_b32 v27, s101
  v_mov_b32 v2, s100
  buffer_load_dword v3, v2, s[40:43], 0 offen sc1
  v_lshl_add_u32 v4, v6, 3, v2
  buffer_load_dwordx2 v[90:91], v4, s[40:43], 0 offen offset:64 sc1
  v_add_u32 v4, 4096, v4
  buffer_load_dwordx2 v[92:93], v4, s[40:43], 0 offen offset:64 sc1
  v_add_u32 v4, 4096, v4
  buffer_load_dwordx2 v[94:95], v4, s[40:43], 0 offen offset:64 sc1
  v_add_u32 v4, 4096, v4
  buffer_load_dwordx2 v[96:97], v4, s[40:43], 0 offen offset:64 sc1
  v_add_u32 v4, 4096, v4
  s_waitcnt vmcnt(0)
  v_readfirstlane_b32 s100, v3
  s_cmp_le_u32 s100, 2048
  s_cselect_b32 s66, 4, s66
  v_cmp_lt_u32 vcc, v6, v3
  v_cmp_eq_u32 s[74:75], s2, v91
  s_and_b64 vcc, vcc, s[74:75]
  v_add_u32 v6, 512, v6
  s_nop 1
  v_cndmask_b32 v122, 0, v90, vcc
  v_cmp_lt_u32 vcc, v6, v3
  v_cmp_eq_u32 s[74:75], s2, v93
  s_and_b64 vcc, vcc, s[74:75]
  v_add_u32 v6, 512, v6
  s_nop 1
  v_cndmask_b32 v123, 0, v92, vcc
  v_cmp_lt_u32 vcc, v6, v3
  v_cmp_eq_u32 s[74:75], s2, v95
  s_and_b64 vcc, vcc, s[74:75]
  v_add_u32 v6, 512, v6
  s_nop 1
  v_cndmask_b32 v124, 0, v94, vcc
  v_cmp_lt_u32 vcc, v6, v3
  v_cmp_eq_u32 s[74:75], s2, v97
  s_and_b64 vcc, vcc, s[74:75]
  v_add_u32 v6, 512, v6
  s_nop 1
  v_cndmask_b32 v125, 0, v96, vcc
  v_mov_b32 v126, 0
  v_mov_b32 v127, 0
  v_mov_b32 v128, 0
  v_mov_b32 v129, 0
  s_branch K_ROUND
.section .rodata,"a"
.p2align 6
.amdhsa_kernel standalone__mpnn_edge_mlp__graph_kernel
  .amdhsa_next_free_vgpr 240
  .amdhsa_next_free_sgpr 102
  .amdhsa_accum_offset 240
  .amdhsa_group_segment_fixed_size 0
  .amdhsa_kernarg_size 72
  .amdhsa_user_sgpr_count 2
  .amdhsa_user_sgpr_kernarg_segment_ptr 1
  .amdhsa_system_sgpr_workgroup_id_x 1
.end_amdhsa_kernel
```
